```python
import torch

def _softmax(x, axis=-1):
    return torch.softmax(x, dim=axis)
def _gelu(x):
    return torch.nn.functional.gelu(x, approximate="tanh")
def _silu(x):
    return torch.nn.functional.silu(x)
def _sigmoid(x):
    return torch.sigmoid(x)
def _layernorm(x, axis=-1, eps=1e-5):
    m = x.mean(dim=axis, keepdim=True)
    v = x.var(dim=axis, keepdim=True, unbiased=False)
    return (x - m) / torch.sqrt(v + eps)
def _scatter_add(tgt, idx, src, axis=0):
    return tgt.clone().index_add_(axis, idx, src)
def _segment_sum(src, seg, n):
    out = torch.zeros((n,) + src.shape[1:], dtype=src.dtype)
    return out.index_add_(0, seg, src)
def _pad(x, pw):
    flat = tuple(v for pair in reversed(pw) for v in pair)
    return torch.nn.functional.pad(x, flat)

kernel_name = 'gated_mix__mha_block__dense_activation_squared_relu__prompt'

def setup_inputs():

    _w = (lambda a: (lambda t: t.to(torch.bfloat16) if t.is_floating_point() else t)(torch.as_tensor(a)))
    def _A_setup():
        B, S, D, H = 1, 2048, 640, 32
        return {
            "x": _w((lambda *s: torch.randn(*s, dtype=torch.bfloat16) * 0.05)(B, S, D)),
            "wqkv": _w((lambda *s: torch.randn(*s, dtype=torch.bfloat16) * 0.8)(D, 3 * D)),
            "wo": _w((lambda *s: torch.randn(*s, dtype=torch.bfloat16) * 0.1)(D, D)),
        }
    _A_in = _A_setup()

    def _B_setup():
        B, S, D, F = 1, 2048, 640, 1728
        return {
            "x": _w((lambda *s: torch.randn(*s, dtype=torch.bfloat16) * 0.05)(B, S, D)),
            "w1": _w((lambda *s: torch.randn(*s, dtype=torch.bfloat16) * 0.1)(D, F)),
            "b1": _w((lambda *s: torch.randn(*s, dtype=torch.bfloat16) * 0.1)(F)),
            "w2": _w((lambda *s: torch.randn(*s, dtype=torch.bfloat16) * 0.1)(F, D)),
            "b2": _w((lambda *s: torch.randn(*s, dtype=torch.bfloat16) * 0.05)(D)),
        }
    _B_in = _B_setup()

    return {
        "A_x": _A_in["x"],
        "A_wqkv": _A_in["wqkv"],
        "A_wo": _A_in["wo"],
        "B_x": _B_in["x"],
        "B_w1": _B_in["w1"],
        "B_b1": _B_in["b1"],
        "B_w2": _B_in["w2"],
        "B_b2": _B_in["b2"],
        "gate_w": _w((lambda *s: torch.randn(*s, dtype=torch.bfloat16) * 0.05)(640) * 16.0),
    }

def reference(A_x, A_wqkv, A_wo, B_x, B_w1, B_b1, B_w2, B_b2, gate_w):
    def _A_ref(x, wqkv, wo):
        B, S, D = x.shape
        H = 32
        Dh = D // H
        qkv = (lambda x, *d: x.permute(*d))((x @ wqkv).reshape(B, S, 3, H, Dh), 2, 0, 3, 1, 4)
        q, k, v = qkv[0], qkv[1], qkv[2]
        scores = torch.einsum("bhqd,bhkd->bhqk", q, k) * (Dh ** -0.5)
        p = _softmax(scores, axis=-1)
        o = torch.einsum("bhqk,bhkd->bhqd", p, v)
        return (lambda x, *d: x.permute(*d))(o, 0, 2, 1, 3).reshape(B, S, D) @ wo

    def _B_ref(x, w1, b1, w2, b2):
        h = torch.einsum("bsd,df->bsf", x, w1) + b1
        zero = torch.zeros_like(h)
        r = torch.where(h > zero, h, zero)
        h = r * r
        out = torch.einsum("bsf,fd->bsd", h, w2) + b2
        return out

    x = A_x
    g = _sigmoid((x * gate_w).sum(-1, keepdims=True))
    a = _A_ref(x, A_wqkv, A_wo)
    b = _B_ref(x, B_w1, B_b1, B_w2, B_b2)
    return g * a + (1 - g) * b
```

```asm
; @launch grid=(256,1,1) block=(512,1,1) lds=163840
.amdgcn_target "amdgcn-amd-amdhsa--gfx950"
.text
.globl gated_mix__mha_block__dense_activation_squared_relu__prompt_kernel
.p2align 12
.p2align 8
.type gated_mix__mha_block__dense_activation_squared_relu__prompt_kernel,@function
gated_mix__mha_block__dense_activation_squared_relu__prompt_kernel:
    s_load_dwordx16 s[16:31], s[0:1], 0
    s_load_dwordx8 s[32:39], s[0:1], 64
    v_lshrrev_b32 v221, 6, v0
    s_cmp_ge_u32 s2, 256
    s_cbranch_scc1 L_end
    v_readfirstlane_b32 s3, v221
    v_and_b32 v0, 63, v0
    s_and_b32 s4, s2, 7
    s_lshr_b32 s5, s2, 3
    s_mov_b32 s42, 2621440
    s_mov_b32 s43, 0x20000
    s_mov_b32 s46, 2457600
    s_mov_b32 s47, 0x20000
    s_lshl3_add_u32 s11, s5, s3
    s_and_b32 s12, s4, 3
    s_lshr_b32 s13, s4, 2
    s_lshl1_add_u32 s14, s12, s13
    s_lshl_b32 s14, s14, 8
    s_add_u32 s14, s14, s11
    s_mulk_i32 s14, 1280
    v_lshlrev_b32 v254, 7, v0
    s_mulk_i32 s11, 10
    v_add_u32 v251, s11, v0
    v_lshrrev_b32 v252, 4, v251
    v_lshl_add_u32 v252, v252, 2, s12
    v_and_b32 v251, 15, v251
    v_lshlrev_b32 v251, 7, v251
    s_movk_i32 s11, 3840
    v_mad_u32_u24 v253, v252, s11, v251
    s_mul_i32 s12, s13, 1792
    s_waitcnt lgkmcnt(0)
    s_mov_b64 s[40:41], s[16:17]
    s_mov_b64 s[44:45], s[18:19]
    s_mov_b64 exec, 0x3ff
    buffer_load_dword v250, v254, s[40:43], s14 offen
    buffer_load_dword v253, v253, s[44:47], s12 offen
    s_mov_b64 exec, -1
    s_lshr_b32 s11, s4, 2
    s_cmp_ge_u32 s5, 30
    s_cselect_b32 s12, 2, 30
    s_cselect_b32 s13, 30, 0
    s_mul_i32 s11, s11, s12
    s_add_u32 s11, s11, s5
    s_add_u32 s11, s11, s13
    s_lshr_b32 s7, s11, 2
    s_and_b32 s11, s11, 3
    s_and_b32 s12, s4, 3
    s_lshl2_add_u32 s6, s12, s11
    s_lshl_b32 s10, s3, 11
    v_and_b32 v240, 15, v0
    v_lshrrev_b32 v241, 4, v0
    v_lshrrev_b32 v221, 3, v0
    v_and_b32 v222, 7, v0
    v_xor_b32 v222, v222, v241
    s_lshl3_add_u32 s11, s6, s3
    s_mulk_i32 s11, 20480
    v_mul_u32_u24 v221, 1280, v221
    v_lshl_add_u32 v221, v222, 4, v221
    v_add_u32 v1, s11, v221
    v_xor_b32 v2, 64, v1
    v_add_u32 v2, 9216, v2
    s_and_b32 s11, s3, 1
    s_lshl_b32 s11, s11, 3
    v_lshl_or_b32 v229, v241, 1, s11
    v_xor_b32 v229, v229, v240
    s_mul_i32 s11, s3, 30720
    s_lshl_b32 s12, s7, 8
    s_add_u32 s11, s11, s12
    v_mul_u32_u24 v222, 3840, v241
    v_lshl_add_u32 v222, v229, 4, v222
    v_add_u32 v3, s11, v222
    s_cmp_eq_u32 s7, 15
    s_cbranch_scc1 L_p1z
    s_and_b32 s8, s3, 3
    s_lshr_b32 s9, s3, 2
    s_lshl_b32 s11, s8, 12
    v_lshrrev_b32 v221, 1, v240
    v_xor_b32 v221, v221, v241
    v_lshl_add_u32 v221, v221, 4, s11
    v_lshl_add_u32 v5, v240, 7, v221
    v_xor_b32 v6, 64, v5
    v_lshrrev_b32 v222, 2, v240
    v_lshl_add_u32 v221, v241, 3, v222
    v_lshlrev_b32 v221, 8, v221
    v_xor_b32 v223, s9, v241
    v_and_b32 v223, 1, v223
    v_lshl_add_u32 v222, v223, 2, v222
    v_lshlrev_b32 v222, 1, v222
    v_and_b32 v223, 3, v240
    v_lshrrev_b32 v225, 1, v223
    v_xor_b32 v224, v225, v222
    v_lshl_add_u32 v224, v224, 4, v221
    v_and_b32 v226, 1, v223
    v_lshl_add_u32 v15, v226, 3, v224
    s_mul_i32 s93, s7, 52
    s_lshr_b32 s93, s93, 8
    s_mov_b64 s[52:53], s[38:39]
    s_mov_b32 s54, 18644992
    s_mov_b32 s55, 0x20000
    s_mov_b64 s[76:77], s[36:37]
    s_mov_b32 s78, 256
    s_mov_b32 s79, 0x20000
    s_mov_b64 s[48:49], s[24:25]
    s_mov_b32 s50, 2211840
    s_mov_b32 s51, 0x20000
    s_mov_b64 s[60:61], s[26:27]
    s_mov_b32 s62, 3456
    s_mov_b32 s63, 0x20000
    s_mov_b64 s[64:65], s[30:31]
    s_mov_b32 s66, 1280
    s_mov_b32 s67, 0x20000
    s_mov_b64 s[68:69], s[32:33]
    s_mov_b32 s70, 1280
    s_mov_b32 s71, 0x20000
    s_mov_b64 s[56:57], s[20:21]
    s_mov_b32 s58, 819200
    s_mov_b32 s59, 0x20000
    s_mov_b64 s[72:73], s[34:35]
    s_mov_b32 s74, 2621440
    s_mov_b32 s75, 0x20000
    v_mul_u32_u24 v231, 3456, v241
    v_lshl_add_u32 v231, v229, 4, v231
    s_lshl_b32 s11, s7, 8
    s_mul_i32 s12, s3, 27648
    s_add_u32 s11, s11, s12
    v_add_u32 v4, s11, v231
    s_lshl_b32 s11, s7, 4
    s_sub_u32 s11, 215, s11
    v_sub_u32 v231, s11, v229
    v_and_b32 v231, 1073741824, v231
    v_or_b32 v4, v4, v231
    s_lshr_b32 s12, s5, 3
    s_lshl2_add_u32 s80, s4, s12
    s_and_b32 s12, s5, 3
    s_lshl2_add_u32 s82, s4, s12
    s_lshr_b32 s83, s5, 2
    s_and_b32 s12, s5, 7
    s_lshl3_add_u32 s81, s12, s3
    s_lshl2_add_u32 s84, s6, s8
    s_mul_i32 s11, s93, 5
    s_sub_u32 s94, s7, s11
    s_mov_b32 s86, 0x000fffff
    s_mov_b32 s87, 0x000fffff
    s_lshl_b32 s11, s80, 6
    s_add_u32 s11, s11, s81
    s_mulk_i32 s11, 1280
    s_add_u32 s90, s11, 65536
    s_mul_i32 s11, s84, 14
    s_add_u32 s11, s11, s7
    s_lshl1_add_u32 s11, s11, s9
    s_lshl_b32 s11, s11, 12
    s_add_u32 s95, s11, 7929856
    s_lshl4_add_u32 s11, s80, s3
    s_mulk_i32 s11, 10240
    s_add_u32 s101, s11, 2686976
    s_mul_i32 s1, s3, 5120
    s_lshl1_add_u32 s11, s7, s9
    s_lshl_b32 s11, s11, 7
    v_lshl_add_u32 v230, v241, 3, s11
    buffer_load_dwordx2 v[18:19], v230, s[60:63], 0 offen offset:0
    buffer_load_dwordx2 v[22:23], v230, s[60:63], 0 offen offset:32
    buffer_load_dwordx2 v[26:27], v230, s[60:63], 0 offen offset:64
    buffer_load_dwordx2 v[30:31], v230, s[60:63], 0 offen offset:96
L_code0:
    s_cmp_eq_u32 s93, 2
    s_cbranch_scc1 L_p1v
    v_xor_b32 v224, v223, v222
    v_lshl_add_u32 v224, v224, 4, v221
    v_lshl_add_u32 v7, v225, 3, v224
    v_xor_b32 v8, 8, v7
    v_xor_b32 v9, 64, v7
    v_xor_b32 v10, 72, v7
    s_lshl1_add_u32 s12, s94, s9
    s_lshl_b32 s12, s12, 3
    s_lshl_b32 s14, 1280, s93
    s_lshl_b32 s13, s14, 6
    s_mul_i32 s14, s14, s84
    s_cmp_eq_u32 s93, 0
    s_mov_b32 s15, 2686976
    s_cselect_b32 s15, 65536, s15
    s_cselect_b32 s85, 0x3ea52b5c, 1.0
    s_cselect_b32 s92, 0xfffe0000, -1
    s_cselect_b32 s91, 0x10000, 0
    s_add_u32 s88, s14, s15
    v_lshrrev_b32 v227, 1, v241
    v_add3_u32 v224, v241, s12, 0
    v_mul_u32_u24 v225, 410, v224
    v_lshrrev_b32 v225, 10, v225
    v_mad_u32_u24 v226, v225, 5, 1
    v_lshrrev_b32 v226, 1, v226
    v_sub_u32 v226, v224, v226
    v_cmp_eq_u32 s[96:97], 2, v226
    v_lshlrev_b32 v226, 9, v226
    v_lshl_add_u32 v226, v240, 4, v226
    v_mad_u32_u24 v11, v225, s13, v226
    v_add_u32 v12, 256, v11
    v_xor_b32 v228, 1, v227
    s_mov_b64 exec, s[96:97]
    v_mad_u32_u24 v12, v228, s13, v11
    v_mad_u32_u24 v11, v227, s13, v11
    s_mov_b64 exec, -1
    v_add3_u32 v224, v241, s12, 4
    v_mul_u32_u24 v225, 410, v224
    v_lshrrev_b32 v225, 10, v225
    v_mad_u32_u24 v226, v225, 5, 1
    v_lshrrev_b32 v226, 1, v226
    v_sub_u32 v226, v224, v226
    v_cmp_eq_u32 s[98:99], 2, v226
    v_lshlrev_b32 v226, 9, v226
    v_lshl_add_u32 v226, v240, 4, v226
    v_mad_u32_u24 v13, v225, s13, v226
    v_add_u32 v14, 256, v13
    v_xor_b32 v228, 1, v227
    s_mov_b64 exec, s[98:99]
    v_mad_u32_u24 v14, v228, s13, v13
    v_mad_u32_u24 v13, v227, s13, v13
    s_mov_b64 exec, -1
    s_add_u32 m0, s10, 0
    s_mov_b32 s100, 0
    buffer_load_dwordx4 v1, s[40:43], s100 offen lds
    buffer_load_dwordx4 v2, s[40:43], s100 offen offset:1024 lds
    s_add_u32 m0, s10, 16384
    s_mov_b32 s100, 0
    buffer_load_dwordx4 v3, s[44:47], s100 offen lds
    s_mov_b32 s100, 14336
    buffer_load_dwordx4 v3, s[44:47], s100 offen offset:1024 lds
    s_barrier
    s_add_u32 m0, s10, 32768
    s_mov_b32 s100, 128
    buffer_load_dwordx4 v1, s[40:43], s100 offen lds
    buffer_load_dwordx4 v2, s[40:43], s100 offen offset:1024 lds
    s_add_u32 m0, s10, 49152
    s_mov_b32 s100, 245760
    buffer_load_dwordx4 v3, s[44:47], s100 offen lds
    s_mov_b32 s100, 260096
    buffer_load_dwordx4 v3, s[44:47], s100 offen offset:1024 lds
    s_waitcnt vmcnt(4)
    s_barrier
    ds_read_b128 v[96:99], v5 offset:0
    ds_read_b64_tr_b16 v[64:65], v7 offset:16384
    ds_read_b64_tr_b16 v[66:67], v7 offset:17408
    ds_read_b128 v[100:103], v5 offset:2048
    ds_read_b64_tr_b16 v[68:69], v8 offset:16384
    ds_read_b64_tr_b16 v[70:71], v8 offset:17408
    ds_read_b64_tr_b16 v[72:73], v9 offset:16384
    ds_read_b64_tr_b16 v[74:75], v9 offset:17408
    ds_read_b64_tr_b16 v[76:77], v10 offset:16384
    ds_read_b64_tr_b16 v[78:79], v10 offset:17408
    s_setprio 1
    s_waitcnt lgkmcnt(7)
    v_mfma_f32_16x16x32_bf16 v[32:35], v[64:67], v[96:99], 0
    ds_read_b128 v[104:107], v6 offset:0
    ds_read_b64_tr_b16 v[80:81], v7 offset:24576
    s_add_u32 m0, s10, 65536
    s_mov_b32 s100, 256
    buffer_load_dwordx4 v1, s[40:43], s100 offen lds
    s_waitcnt lgkmcnt(8)
    v_mfma_f32_16x16x32_bf16 v[36:39], v[64:67], v[100:103], 0
    ds_read_b64_tr_b16 v[82:83], v7 offset:25600
    s_waitcnt lgkmcnt(7)
    v_mfma_f32_16x16x32_bf16 v[40:43], v[68:71], v[96:99], 0
    ds_read_b128 v[108:111], v6 offset:2048
    buffer_load_dwordx4 v2, s[40:43], s100 offen offset:1024 lds
    v_mfma_f32_16x16x32_bf16 v[44:47], v[68:71], v[100:103], 0
    ds_read_b64_tr_b16 v[84:85], v8 offset:24576
    s_setprio 0
    s_waitcnt lgkmcnt(7)
    v_mfma_f32_16x16x32_bf16 v[48:51], v[72:75], v[96:99], 0
    ds_read_b64_tr_b16 v[86:87], v8 offset:25600
    ds_read_b64_tr_b16 v[88:89], v9 offset:24576
    s_add_u32 m0, s10, 81920
    s_mov_b32 s100, 491520
    buffer_load_dwordx4 v3, s[44:47], s100 offen lds
    v_mfma_f32_16x16x32_bf16 v[52:55], v[72:75], v[100:103], 0
    ds_read_b64_tr_b16 v[90:91], v9 offset:25600
    s_waitcnt lgkmcnt(8)
    v_mfma_f32_16x16x32_bf16 v[56:59], v[76:79], v[96:99], 0
    ds_read_b64_tr_b16 v[92:93], v10 offset:24576
    s_mov_b32 s100, 505856
    buffer_load_dwordx4 v3, s[44:47], s100 offen offset:1024 lds
    v_mfma_f32_16x16x32_bf16 v[60:63], v[76:79], v[100:103], 0
    ds_read_b64_tr_b16 v[94:95], v10 offset:25600
    s_waitcnt vmcnt(4)
    s_barrier
    s_setprio 3
    s_waitcnt lgkmcnt(7)
    v_mfma_f32_16x16x32_bf16 v[32:35], v[80:83], v[104:107], v[32:35]
    ds_read_b128 v[112:115], v5 offset:32768
    ds_read_b64_tr_b16 v[64:65], v7 offset:49152
    s_add_u32 m0, s10, 98304
    s_mov_b32 s100, 384
    buffer_load_dwordx4 v1, s[40:43], s100 offen lds
    s_waitcnt lgkmcnt(8)
    v_mfma_f32_16x16x32_bf16 v[36:39], v[80:83], v[108:111], v[36:39]
    ds_read_b64_tr_b16 v[66:67], v7 offset:50176
    s_waitcnt lgkmcnt(7)
    v_mfma_f32_16x16x32_bf16 v[40:43], v[84:87], v[104:107], v[40:43]
    ds_read_b128 v[116:119], v5 offset:34816
    v_mfma_f32_16x16x32_bf16 v[44:47], v[84:87], v[108:111], v[44:47]
    ds_read_b64_tr_b16 v[68:69], v8 offset:49152
    buffer_load_dwordx4 v2, s[40:43], s100 offen offset:1024 lds
    s_setprio 2
    s_waitcnt lgkmcnt(7)
    v_mfma_f32_16x16x32_bf16 v[48:51], v[88:91], v[104:107], v[48:51]
    ds_read_b64_tr_b16 v[70:71], v8 offset:50176
    ds_read_b64_tr_b16 v[72:73], v9 offset:49152
    v_mfma_f32_16x16x32_bf16 v[52:55], v[88:91], v[108:111], v[52:55]
    ds_read_b64_tr_b16 v[74:75], v9 offset:50176
    s_waitcnt lgkmcnt(8)
    v_mfma_f32_16x16x32_bf16 v[56:59], v[92:95], v[104:107], v[56:59]
    ds_read_b64_tr_b16 v[76:77], v10 offset:49152
    s_add_u32 m0, s10, 114688
    s_mov_b32 s100, 737280
    buffer_load_dwordx4 v3, s[44:47], s100 offen lds
    v_mfma_f32_16x16x32_bf16 v[60:63], v[92:95], v[108:111], v[60:63]
    ds_read_b64_tr_b16 v[78:79], v10 offset:50176
    s_setprio 1
    s_waitcnt lgkmcnt(7)
    v_mfma_f32_16x16x32_bf16 v[32:35], v[64:67], v[112:115], v[32:35]
    ds_read_b128 v[120:123], v6 offset:32768
    ds_read_b64_tr_b16 v[80:81], v7 offset:57344
    s_waitcnt lgkmcnt(8)
    v_mfma_f32_16x16x32_bf16 v[36:39], v[64:67], v[116:119], v[36:39]
    ds_read_b64_tr_b16 v[82:83], v7 offset:58368
    s_mov_b32 s100, 751616
    buffer_load_dwordx4 v3, s[44:47], s100 offen offset:1024 lds
    s_waitcnt lgkmcnt(7)
    v_mfma_f32_16x16x32_bf16 v[40:43], v[68:71], v[112:115], v[40:43]
    ds_read_b128 v[124:127], v6 offset:34816
    v_mfma_f32_16x16x32_bf16 v[44:47], v[68:71], v[116:119], v[44:47]
    ds_read_b64_tr_b16 v[84:85], v8 offset:57344
    s_setprio 0
    s_waitcnt lgkmcnt(7)
    v_mfma_f32_16x16x32_bf16 v[48:51], v[72:75], v[112:115], v[48:51]
    ds_read_b64_tr_b16 v[86:87], v8 offset:58368
    ds_read_b64_tr_b16 v[88:89], v9 offset:57344
    v_mfma_f32_16x16x32_bf16 v[52:55], v[72:75], v[116:119], v[52:55]
    ds_read_b64_tr_b16 v[90:91], v9 offset:58368
    s_waitcnt lgkmcnt(8)
    v_mfma_f32_16x16x32_bf16 v[56:59], v[76:79], v[112:115], v[56:59]
    ds_read_b64_tr_b16 v[92:93], v10 offset:57344
    v_mfma_f32_16x16x32_bf16 v[60:63], v[76:79], v[116:119], v[60:63]
    ds_read_b64_tr_b16 v[94:95], v10 offset:58368
    v_add_u32 v5, 0x10000, v5
    v_add_u32 v6, 0x10000, v6
    v_add_u32 v7, 0x10000, v7
    v_add_u32 v8, 0x10000, v8
    v_add_u32 v9, 0x10000, v9
    v_add_u32 v10, 0x10000, v10
    s_waitcnt vmcnt(4)
    s_barrier
    s_lshl3_add_u32 s15, s2, s3
    s_mul_i32 s100, s15, 1152
    s_mov_b64 exec, 0x1ff
    buffer_load_dword v251, v254, s[48:51], s100 offen
    s_lshl_b32 s100, s15, 8
    s_add_u32 s100, s100, 327680
    s_mov_b64 exec, 3
    buffer_load_dword v252, v254, s[56:59], s100 offen
    s_mov_b64 exec, -1
    s_setprio 3
    s_waitcnt lgkmcnt(7)
    v_mfma_f32_16x16x32_bf16 v[32:35], v[80:83], v[120:123], v[32:35]
    ds_read_b128 v[128:131], v5 offset:0
    ds_read_b64_tr_b16 v[64:65], v7 offset:16384
    s_add_u32 m0, s10, 131072
    s_mov_b32 s100, 512
    buffer_load_dwordx4 v1, s[40:43], s100 offen lds
    s_waitcnt lgkmcnt(8)
    v_mfma_f32_16x16x32_bf16 v[36:39], v[80:83], v[124:127], v[36:39]
    ds_read_b64_tr_b16 v[66:67], v7 offset:17408
    s_waitcnt lgkmcnt(7)
    v_mfma_f32_16x16x32_bf16 v[40:43], v[84:87], v[120:123], v[40:43]
    ds_read_b128 v[132:135], v5 offset:2048
    v_mfma_f32_16x16x32_bf16 v[44:47], v[84:87], v[124:127], v[44:47]
    ds_read_b64_tr_b16 v[68:69], v8 offset:16384
    buffer_load_dwordx4 v2, s[40:43], s100 offen offset:1024 lds
    s_setprio 2
    s_waitcnt lgkmcnt(7)
    v_mfma_f32_16x16x32_bf16 v[48:51], v[88:91], v[120:123], v[48:51]
    ds_read_b64_tr_b16 v[70:71], v8 offset:17408
    ds_read_b64_tr_b16 v[72:73], v9 offset:16384
    v_mfma_f32_16x16x32_bf16 v[52:55], v[88:91], v[124:127], v[52:55]
    ds_read_b64_tr_b16 v[74:75], v9 offset:17408
    s_waitcnt lgkmcnt(8)
    v_mfma_f32_16x16x32_bf16 v[56:59], v[92:95], v[120:123], v[56:59]
    ds_read_b64_tr_b16 v[76:77], v10 offset:16384
    s_add_u32 m0, s10, 147456
    s_mov_b32 s100, 983040
    buffer_load_dwordx4 v3, s[44:47], s100 offen lds
    v_mfma_f32_16x16x32_bf16 v[60:63], v[92:95], v[124:127], v[60:63]
    ds_read_b64_tr_b16 v[78:79], v10 offset:17408
    s_setprio 1
    s_waitcnt lgkmcnt(7)
    v_mfma_f32_16x16x32_bf16 v[32:35], v[64:67], v[128:131], v[32:35]
    ds_read_b128 v[136:139], v6 offset:0
    ds_read_b64_tr_b16 v[80:81], v7 offset:24576
    s_waitcnt lgkmcnt(8)
    v_mfma_f32_16x16x32_bf16 v[36:39], v[64:67], v[132:135], v[36:39]
    ds_read_b64_tr_b16 v[82:83], v7 offset:25600
    s_mov_b32 s100, 997376
    buffer_load_dwordx4 v3, s[44:47], s100 offen offset:1024 lds
    s_waitcnt lgkmcnt(7)
    v_mfma_f32_16x16x32_bf16 v[40:43], v[68:71], v[128:131], v[40:43]
    ds_read_b128 v[140:143], v6 offset:2048
    v_mfma_f32_16x16x32_bf16 v[44:47], v[68:71], v[132:135], v[44:47]
    ds_read_b64_tr_b16 v[84:85], v8 offset:24576
    s_setprio 0
    s_waitcnt lgkmcnt(7)
    v_mfma_f32_16x16x32_bf16 v[48:51], v[72:75], v[128:131], v[48:51]
    ds_read_b64_tr_b16 v[86:87], v8 offset:25600
    ds_read_b64_tr_b16 v[88:89], v9 offset:24576
    v_mfma_f32_16x16x32_bf16 v[52:55], v[72:75], v[132:135], v[52:55]
    ds_read_b64_tr_b16 v[90:91], v9 offset:25600
    s_waitcnt lgkmcnt(8)
    v_mfma_f32_16x16x32_bf16 v[56:59], v[76:79], v[128:131], v[56:59]
    ds_read_b64_tr_b16 v[92:93], v10 offset:24576
    v_mfma_f32_16x16x32_bf16 v[60:63], v[76:79], v[132:135], v[60:63]
    ds_read_b64_tr_b16 v[94:95], v10 offset:25600
    s_waitcnt vmcnt(6)
    s_barrier
    s_setprio 3
    s_waitcnt lgkmcnt(7)
    v_mfma_f32_16x16x32_bf16 v[32:35], v[80:83], v[136:139], v[32:35]
    ds_read_b128 v[144:147], v5 offset:32768
    ds_read_b64_tr_b16 v[64:65], v7 offset:49152
    s_add_u32 m0, s10, 0
    s_mov_b32 s100, 640
    buffer_load_dwordx4 v1, s[40:43], s100 offen lds
    s_waitcnt lgkmcnt(8)
    v_mfma_f32_16x16x32_bf16 v[36:39], v[80:83], v[140:143], v[36:39]
    ds_read_b64_tr_b16 v[66:67], v7 offset:50176
    v_lshlrev_b32 v16, 16, v18
    s_waitcnt lgkmcnt(7)
    v_mfma_f32_16x16x32_bf16 v[40:43], v[84:87], v[136:139], v[40:43]
    ds_read_b128 v[148:151], v5 offset:34816
    v_mfma_f32_16x16x32_bf16 v[44:47], v[84:87], v[140:143], v[44:47]
    ds_read_b64_tr_b16 v[68:69], v8 offset:49152
    buffer_load_dwordx4 v2, s[40:43], s100 offen offset:1024 lds
    s_setprio 2
    s_waitcnt lgkmcnt(7)
    v_mfma_f32_16x16x32_bf16 v[48:51], v[88:91], v[136:139], v[48:51]
    ds_read_b64_tr_b16 v[70:71], v8 offset:50176
    ds_read_b64_tr_b16 v[72:73], v9 offset:49152
    v_and_b32 v17, 0xffff0000, v18
    v_mfma_f32_16x16x32_bf16 v[52:55], v[88:91], v[140:143], v[52:55]
    ds_read_b64_tr_b16 v[74:75], v9 offset:50176
    s_waitcnt lgkmcnt(8)
    v_mfma_f32_16x16x32_bf16 v[56:59], v[92:95], v[136:139], v[56:59]
    ds_read_b64_tr_b16 v[76:77], v10 offset:49152
    s_add_u32 m0, s10, 16384
    s_mov_b32 s100, 1228800
    buffer_load_dwordx4 v3, s[44:47], s100 offen lds
    v_mfma_f32_16x16x32_bf16 v[60:63], v[92:95], v[140:143], v[60:63]
    ds_read_b64_tr_b16 v[78:79], v10 offset:50176
    v_lshlrev_b32 v18, 16, v19
    s_setprio 1
    s_waitcnt lgkmcnt(7)
    v_mfma_f32_16x16x32_bf16 v[32:35], v[64:67], v[144:147], v[32:35]
    ds_read_b128 v[152:155], v6 offset:32768
    ds_read_b64_tr_b16 v[80:81], v7 offset:57344
    s_waitcnt lgkmcnt(8)
    v_mfma_f32_16x16x32_bf16 v[36:39], v[64:67], v[148:151], v[36:39]
    ds_read_b64_tr_b16 v[82:83], v7 offset:58368
    s_mov_b32 s100, 1243136
    buffer_load_dwordx4 v3, s[44:47], s100 offen offset:1024 lds
    s_waitcnt lgkmcnt(7)
    v_mfma_f32_16x16x32_bf16 v[40:43], v[68:71], v[144:147], v[40:43]
    ds_read_b128 v[156:159], v6 offset:34816
    v_and_b32 v19, 0xffff0000, v19
    v_mfma_f32_16x16x32_bf16 v[44:47], v[68:71], v[148:151], v[44:47]
    ds_read_b64_tr_b16 v[84:85], v8 offset:57344
    s_setprio 0
    s_waitcnt lgkmcnt(7)
    v_mfma_f32_16x16x32_bf16 v[48:51], v[72:75], v[144:147], v[48:51]
    ds_read_b64_tr_b16 v[86:87], v8 offset:58368
    ds_read_b64_tr_b16 v[88:89], v9 offset:57344
    v_mfma_f32_16x16x32_bf16 v[52:55], v[72:75], v[148:151], v[52:55]
    ds_read_b64_tr_b16 v[90:91], v9 offset:58368
    s_waitcnt lgkmcnt(8)
    v_mfma_f32_16x16x32_bf16 v[56:59], v[76:79], v[144:147], v[56:59]
    ds_read_b64_tr_b16 v[92:93], v10 offset:57344
    v_mfma_f32_16x16x32_bf16 v[60:63], v[76:79], v[148:151], v[60:63]
    ds_read_b64_tr_b16 v[94:95], v10 offset:58368
    v_add_u32 v5, 0x10000, v5
    v_add_u32 v6, 0x10000, v6
    v_add_u32 v7, 0x10000, v7
    v_add_u32 v8, 0x10000, v8
    v_add_u32 v9, 0x10000, v9
    v_add_u32 v10, 0x10000, v10
    s_waitcnt vmcnt(4)
    s_barrier
    s_setprio 3
    s_waitcnt lgkmcnt(7)
    v_mfma_f32_16x16x32_bf16 v[32:35], v[80:83], v[152:155], v[32:35]
    ds_read_b128 v[160:163], v5 offset:0
    ds_read_b64_tr_b16 v[64:65], v7 offset:16384
    s_add_u32 m0, s10, 32768
    s_mov_b32 s100, 768
    buffer_load_dwordx4 v1, s[40:43], s100 offen lds
    s_waitcnt lgkmcnt(8)
    v_mfma_f32_16x16x32_bf16 v[36:39], v[80:83], v[156:159], v[36:39]
    ds_read_b64_tr_b16 v[66:67], v7 offset:17408
    v_lshlrev_b32 v20, 16, v22
    s_waitcnt lgkmcnt(7)
    v_mfma_f32_16x16x32_bf16 v[40:43], v[84:87], v[152:155], v[40:43]
    ds_read_b128 v[164:167], v5 offset:2048
    v_mfma_f32_16x16x32_bf16 v[44:47], v[84:87], v[156:159], v[44:47]
    ds_read_b64_tr_b16 v[68:69], v8 offset:16384
    buffer_load_dwordx4 v2, s[40:43], s100 offen offset:1024 lds
    s_setprio 2
    s_waitcnt lgkmcnt(7)
    v_mfma_f32_16x16x32_bf16 v[48:51], v[88:91], v[152:155], v[48:51]
    ds_read_b64_tr_b16 v[70:71], v8 offset:17408
    ds_read_b64_tr_b16 v[72:73], v9 offset:16384
    v_and_b32 v21, 0xffff0000, v22
    v_mfma_f32_16x16x32_bf16 v[52:55], v[88:91], v[156:159], v[52:55]
    ds_read_b64_tr_b16 v[74:75], v9 offset:17408
    s_waitcnt lgkmcnt(8)
    v_mfma_f32_16x16x32_bf16 v[56:59], v[92:95], v[152:155], v[56:59]
    ds_read_b64_tr_b16 v[76:77], v10 offset:16384
    s_add_u32 m0, s10, 49152
    s_mov_b32 s100, 1474560
    buffer_load_dwordx4 v3, s[44:47], s100 offen lds
    v_mfma_f32_16x16x32_bf16 v[60:63], v[92:95], v[156:159], v[60:63]
    ds_read_b64_tr_b16 v[78:79], v10 offset:17408
    v_lshlrev_b32 v22, 16, v23
    s_setprio 1
    s_waitcnt lgkmcnt(7)
    v_mfma_f32_16x16x32_bf16 v[32:35], v[64:67], v[160:163], v[32:35]
    ds_read_b128 v[168:171], v6 offset:0
    ds_read_b64_tr_b16 v[80:81], v7 offset:24576
    s_waitcnt lgkmcnt(8)
    v_mfma_f32_16x16x32_bf16 v[36:39], v[64:67], v[164:167], v[36:39]
    ds_read_b64_tr_b16 v[82:83], v7 offset:25600
    s_mov_b32 s100, 1488896
    buffer_load_dwordx4 v3, s[44:47], s100 offen offset:1024 lds
    s_waitcnt lgkmcnt(7)
    v_mfma_f32_16x16x32_bf16 v[40:43], v[68:71], v[160:163], v[40:43]
    ds_read_b128 v[172:175], v6 offset:2048
    v_and_b32 v23, 0xffff0000, v23
    v_mfma_f32_16x16x32_bf16 v[44:47], v[68:71], v[164:167], v[44:47]
    ds_read_b64_tr_b16 v[84:85], v8 offset:24576
    s_setprio 0
    s_waitcnt lgkmcnt(7)
    v_mfma_f32_16x16x32_bf16 v[48:51], v[72:75], v[160:163], v[48:51]
    ds_read_b64_tr_b16 v[86:87], v8 offset:25600
    ds_read_b64_tr_b16 v[88:89], v9 offset:24576
    v_mfma_f32_16x16x32_bf16 v[52:55], v[72:75], v[164:167], v[52:55]
    ds_read_b64_tr_b16 v[90:91], v9 offset:25600
    s_waitcnt lgkmcnt(8)
    v_mfma_f32_16x16x32_bf16 v[56:59], v[76:79], v[160:163], v[56:59]
    ds_read_b64_tr_b16 v[92:93], v10 offset:24576
    v_mfma_f32_16x16x32_bf16 v[60:63], v[76:79], v[164:167], v[60:63]
    ds_read_b64_tr_b16 v[94:95], v10 offset:25600
    v_add_u32 v5, 0xfffe0000, v5
    v_add_u32 v6, 0xfffe0000, v6
    v_add_u32 v7, 0xfffe0000, v7
    v_add_u32 v8, 0xfffe0000, v8
    v_add_u32 v9, 0xfffe0000, v9
    v_add_u32 v10, 0xfffe0000, v10
    s_waitcnt vmcnt(4)
    s_barrier
    s_setprio 3
    s_waitcnt lgkmcnt(7)
    v_mfma_f32_16x16x32_bf16 v[32:35], v[80:83], v[168:171], v[32:35]
    ds_read_b128 v[176:179], v5 offset:0
    ds_read_b64_tr_b16 v[64:65], v7 offset:16384
    s_add_u32 m0, s10, 65536
    s_mov_b32 s100, 896
    buffer_load_dwordx4 v1, s[40:43], s100 offen lds
    s_waitcnt lgkmcnt(8)
    v_mfma_f32_16x16x32_bf16 v[36:39], v[80:83], v[172:175], v[36:39]
    ds_read_b64_tr_b16 v[66:67], v7 offset:17408
    v_lshlrev_b32 v24, 16, v26
    s_waitcnt lgkmcnt(7)
    v_mfma_f32_16x16x32_bf16 v[40:43], v[84:87], v[168:171], v[40:43]
    ds_read_b128 v[180:183], v5 offset:2048
    v_mfma_f32_16x16x32_bf16 v[44:47], v[84:87], v[172:175], v[44:47]
    ds_read_b64_tr_b16 v[68:69], v8 offset:16384
    buffer_load_dwordx4 v2, s[40:43], s100 offen offset:1024 lds
    s_setprio 2
    s_waitcnt lgkmcnt(7)
    v_mfma_f32_16x16x32_bf16 v[48:51], v[88:91], v[168:171], v[48:51]
    ds_read_b64_tr_b16 v[70:71], v8 offset:17408
    ds_read_b64_tr_b16 v[72:73], v9 offset:16384
    v_and_b32 v25, 0xffff0000, v26
    v_mfma_f32_16x16x32_bf16 v[52:55], v[88:91], v[172:175], v[52:55]
    ds_read_b64_tr_b16 v[74:75], v9 offset:17408
    s_waitcnt lgkmcnt(8)
    v_mfma_f32_16x16x32_bf16 v[56:59], v[92:95], v[168:171], v[56:59]
    ds_read_b64_tr_b16 v[76:77], v10 offset:16384
    s_add_u32 m0, s10, 81920
    s_mov_b32 s100, 1720320
    buffer_load_dwordx4 v3, s[44:47], s100 offen lds
    v_mfma_f32_16x16x32_bf16 v[60:63], v[92:95], v[172:175], v[60:63]
    ds_read_b64_tr_b16 v[78:79], v10 offset:17408
    v_lshlrev_b32 v26, 16, v27
    s_setprio 1
    s_waitcnt lgkmcnt(7)
    v_mfma_f32_16x16x32_bf16 v[32:35], v[64:67], v[176:179], v[32:35]
    ds_read_b128 v[184:187], v6 offset:0
    ds_read_b64_tr_b16 v[80:81], v7 offset:24576
    s_waitcnt lgkmcnt(8)
    v_mfma_f32_16x16x32_bf16 v[36:39], v[64:67], v[180:183], v[36:39]
    ds_read_b64_tr_b16 v[82:83], v7 offset:25600
    s_mov_b32 s100, 1734656
    buffer_load_dwordx4 v3, s[44:47], s100 offen offset:1024 lds
    s_waitcnt lgkmcnt(7)
    v_mfma_f32_16x16x32_bf16 v[40:43], v[68:71], v[176:179], v[40:43]
    ds_read_b128 v[188:191], v6 offset:2048
    v_and_b32 v27, 0xffff0000, v27
    v_mfma_f32_16x16x32_bf16 v[44:47], v[68:71], v[180:183], v[44:47]
    ds_read_b64_tr_b16 v[84:85], v8 offset:24576
    s_setprio 0
    s_waitcnt lgkmcnt(7)
    v_mfma_f32_16x16x32_bf16 v[48:51], v[72:75], v[176:179], v[48:51]
    ds_read_b64_tr_b16 v[86:87], v8 offset:25600
    ds_read_b64_tr_b16 v[88:89], v9 offset:24576
    v_mfma_f32_16x16x32_bf16 v[52:55], v[72:75], v[180:183], v[52:55]
    ds_read_b64_tr_b16 v[90:91], v9 offset:25600
    s_waitcnt lgkmcnt(8)
    v_mfma_f32_16x16x32_bf16 v[56:59], v[76:79], v[176:179], v[56:59]
    ds_read_b64_tr_b16 v[92:93], v10 offset:24576
    v_mfma_f32_16x16x32_bf16 v[60:63], v[76:79], v[180:183], v[60:63]
    ds_read_b64_tr_b16 v[94:95], v10 offset:25600
    s_waitcnt vmcnt(4)
    s_barrier
    s_setprio 3
    s_waitcnt lgkmcnt(7)
    v_mfma_f32_16x16x32_bf16 v[32:35], v[80:83], v[184:187], v[32:35]
    ds_read_b128 v[192:195], v5 offset:32768
    ds_read_b64_tr_b16 v[64:65], v7 offset:49152
    s_add_u32 m0, s10, 98304
    s_mov_b32 s100, 1024
    buffer_load_dwordx4 v1, s[40:43], s100 offen lds
    s_waitcnt lgkmcnt(8)
    v_mfma_f32_16x16x32_bf16 v[36:39], v[80:83], v[188:191], v[36:39]
    ds_read_b64_tr_b16 v[66:67], v7 offset:50176
    v_lshlrev_b32 v28, 16, v30
    s_waitcnt lgkmcnt(7)
    v_mfma_f32_16x16x32_bf16 v[40:43], v[84:87], v[184:187], v[40:43]
    ds_read_b128 v[196:199], v5 offset:34816
    v_mfma_f32_16x16x32_bf16 v[44:47], v[84:87], v[188:191], v[44:47]
    ds_read_b64_tr_b16 v[68:69], v8 offset:49152
    buffer_load_dwordx4 v2, s[40:43], s100 offen offset:1024 lds
    s_setprio 2
    s_waitcnt lgkmcnt(7)
    v_mfma_f32_16x16x32_bf16 v[48:51], v[88:91], v[184:187], v[48:51]
    ds_read_b64_tr_b16 v[70:71], v8 offset:50176
    ds_read_b64_tr_b16 v[72:73], v9 offset:49152
    v_and_b32 v29, 0xffff0000, v30
    v_mfma_f32_16x16x32_bf16 v[52:55], v[88:91], v[188:191], v[52:55]
    ds_read_b64_tr_b16 v[74:75], v9 offset:50176
    s_waitcnt lgkmcnt(8)
    v_mfma_f32_16x16x32_bf16 v[56:59], v[92:95], v[184:187], v[56:59]
    ds_read_b64_tr_b16 v[76:77], v10 offset:49152
    s_add_u32 m0, s10, 114688
    s_mov_b32 s100, 1966080
    buffer_load_dwordx4 v3, s[44:47], s100 offen lds
    v_mfma_f32_16x16x32_bf16 v[60:63], v[92:95], v[188:191], v[60:63]
    ds_read_b64_tr_b16 v[78:79], v10 offset:50176
    v_lshlrev_b32 v30, 16, v31
    s_setprio 1
    s_waitcnt lgkmcnt(7)
    v_mfma_f32_16x16x32_bf16 v[32:35], v[64:67], v[192:195], v[32:35]
    ds_read_b128 v[200:203], v6 offset:32768
    ds_read_b64_tr_b16 v[80:81], v7 offset:57344
    s_waitcnt lgkmcnt(8)
    v_mfma_f32_16x16x32_bf16 v[36:39], v[64:67], v[196:199], v[36:39]
    ds_read_b64_tr_b16 v[82:83], v7 offset:58368
    s_mov_b32 s100, 1980416
    buffer_load_dwordx4 v3, s[44:47], s100 offen offset:1024 lds
    s_waitcnt lgkmcnt(7)
    v_mfma_f32_16x16x32_bf16 v[40:43], v[68:71], v[192:195], v[40:43]
    ds_read_b128 v[204:207], v6 offset:34816
    v_and_b32 v31, 0xffff0000, v31
    v_mfma_f32_16x16x32_bf16 v[44:47], v[68:71], v[196:199], v[44:47]
    ds_read_b64_tr_b16 v[84:85], v8 offset:57344
    s_setprio 0
    s_waitcnt lgkmcnt(7)
    v_mfma_f32_16x16x32_bf16 v[48:51], v[72:75], v[192:195], v[48:51]
    ds_read_b64_tr_b16 v[86:87], v8 offset:58368
    ds_read_b64_tr_b16 v[88:89], v9 offset:57344
    v_mfma_f32_16x16x32_bf16 v[52:55], v[72:75], v[196:199], v[52:55]
    ds_read_b64_tr_b16 v[90:91], v9 offset:58368
    s_waitcnt lgkmcnt(8)
    v_mfma_f32_16x16x32_bf16 v[56:59], v[76:79], v[192:195], v[56:59]
    ds_read_b64_tr_b16 v[92:93], v10 offset:57344
    v_mfma_f32_16x16x32_bf16 v[60:63], v[76:79], v[196:199], v[60:63]
    ds_read_b64_tr_b16 v[94:95], v10 offset:58368
    v_add_u32 v5, 0x10000, v5
    v_add_u32 v6, 0x10000, v6
    v_add_u32 v7, 0x10000, v7
    v_add_u32 v8, 0x10000, v8
    v_add_u32 v9, 0x10000, v9
    v_add_u32 v10, 0x10000, v10
    s_waitcnt vmcnt(4)
    s_barrier
    s_setprio 3
    s_waitcnt lgkmcnt(7)
    v_mfma_f32_16x16x32_bf16 v[32:35], v[80:83], v[200:203], v[32:35]
    ds_read_b128 v[208:211], v5 offset:0
    ds_read_b64_tr_b16 v[64:65], v7 offset:16384
    s_add_u32 m0, s10, 131072
    s_mov_b32 s100, 1152
    buffer_load_dwordx4 v1, s[40:43], s100 offen lds
    s_waitcnt lgkmcnt(8)
    v_mfma_f32_16x16x32_bf16 v[36:39], v[80:83], v[204:207], v[36:39]
    ds_read_b64_tr_b16 v[66:67], v7 offset:17408
    s_waitcnt lgkmcnt(7)
    v_mfma_f32_16x16x32_bf16 v[40:43], v[84:87], v[200:203], v[40:43]
    ds_read_b128 v[212:215], v5 offset:2048
    v_mfma_f32_16x16x32_bf16 v[44:47], v[84:87], v[204:207], v[44:47]
    ds_read_b64_tr_b16 v[68:69], v8 offset:16384
    buffer_load_dwordx4 v2, s[40:43], s100 offen offset:1024 lds
    s_setprio 2
    s_waitcnt lgkmcnt(7)
    v_mfma_f32_16x16x32_bf16 v[48:51], v[88:91], v[200:203], v[48:51]
    ds_read_b64_tr_b16 v[70:71], v8 offset:17408
    ds_read_b64_tr_b16 v[72:73], v9 offset:16384
    v_mfma_f32_16x16x32_bf16 v[52:55], v[88:91], v[204:207], v[52:55]
    ds_read_b64_tr_b16 v[74:75], v9 offset:17408
    s_waitcnt lgkmcnt(8)
    v_mfma_f32_16x16x32_bf16 v[56:59], v[92:95], v[200:203], v[56:59]
    ds_read_b64_tr_b16 v[76:77], v10 offset:16384
    s_add_u32 m0, s10, 147456
    s_mov_b32 s100, 2211840
    buffer_load_dwordx4 v3, s[44:47], s100 offen lds
    v_mfma_f32_16x16x32_bf16 v[60:63], v[92:95], v[204:207], v[60:63]
    ds_read_b64_tr_b16 v[78:79], v10 offset:17408
    s_setprio 1
    s_waitcnt lgkmcnt(7)
    v_mfma_f32_16x16x32_bf16 v[32:35], v[64:67], v[208:211], v[32:35]
    ds_read_b128 v[216:219], v6 offset:0
    ds_read_b64_tr_b16 v[80:81], v7 offset:24576
    s_waitcnt lgkmcnt(8)
    v_mfma_f32_16x16x32_bf16 v[36:39], v[64:67], v[212:215], v[36:39]
    ds_read_b64_tr_b16 v[82:83], v7 offset:25600
    s_mov_b32 s100, 2226176
    buffer_load_dwordx4 v3, s[44:47], s100 offen offset:1024 lds
    s_waitcnt lgkmcnt(7)
    v_mfma_f32_16x16x32_bf16 v[40:43], v[68:71], v[208:211], v[40:43]
    ds_read_b128 v[220:223], v6 offset:2048
    v_mfma_f32_16x16x32_bf16 v[44:47], v[68:71], v[212:215], v[44:47]
    ds_read_b64_tr_b16 v[84:85], v8 offset:24576
    s_setprio 0
    s_waitcnt lgkmcnt(7)
    v_mfma_f32_16x16x32_bf16 v[48:51], v[72:75], v[208:211], v[48:51]
    ds_read_b64_tr_b16 v[86:87], v8 offset:25600
    ds_read_b64_tr_b16 v[88:89], v9 offset:24576
    v_mfma_f32_16x16x32_bf16 v[52:55], v[72:75], v[212:215], v[52:55]
    ds_read_b64_tr_b16 v[90:91], v9 offset:25600
    s_waitcnt lgkmcnt(8)
    v_mfma_f32_16x16x32_bf16 v[56:59], v[76:79], v[208:211], v[56:59]
    ds_read_b64_tr_b16 v[92:93], v10 offset:24576
    v_mfma_f32_16x16x32_bf16 v[60:63], v[76:79], v[212:215], v[60:63]
    ds_read_b64_tr_b16 v[94:95], v10 offset:25600
    s_waitcnt vmcnt(4)
    s_barrier
    s_setprio 3
    s_waitcnt lgkmcnt(7)
    v_mfma_f32_16x16x32_bf16 v[32:35], v[80:83], v[216:219], v[32:35]
    ds_read_b128 v[224:227], v5 offset:32768
    ds_read_b64_tr_b16 v[64:65], v7 offset:49152
    s_add_u32 m0, s10, 0
    s_mov_b32 s100, 0
    buffer_load_dwordx4 v4, s[48:51], s100 offen lds
    s_waitcnt lgkmcnt(8)
    v_mfma_f32_16x16x32_bf16 v[36:39], v[80:83], v[220:223], v[36:39]
    ds_read_b64_tr_b16 v[66:67], v7 offset:50176
    s_waitcnt lgkmcnt(7)
    v_mfma_f32_16x16x32_bf16 v[40:43], v[84:87], v[216:219], v[40:43]
    ds_read_b128 v[228:231], v5 offset:34816
    v_mfma_f32_16x16x32_bf16 v[44:47], v[84:87], v[220:223], v[44:47]
    ds_read_b64_tr_b16 v[68:69], v8 offset:49152
    s_mov_b32 s100, 12800
    buffer_load_dwordx4 v4, s[48:51], s100 offen offset:1024 lds
    s_setprio 2
    s_waitcnt lgkmcnt(7)
    v_mfma_f32_16x16x32_bf16 v[48:51], v[88:91], v[216:219], v[48:51]
    ds_read_b64_tr_b16 v[70:71], v8 offset:50176
    ds_read_b64_tr_b16 v[72:73], v9 offset:49152
    v_mfma_f32_16x16x32_bf16 v[52:55], v[88:91], v[220:223], v[52:55]
    ds_read_b64_tr_b16 v[74:75], v9 offset:50176
    s_waitcnt lgkmcnt(8)
    v_mfma_f32_16x16x32_bf16 v[56:59], v[92:95], v[216:219], v[56:59]
    ds_read_b64_tr_b16 v[76:77], v10 offset:49152
    s_add_u32 m0, s10, 16384
    s_mov_b32 s100, 221184
    buffer_load_dwordx4 v4, s[48:51], s100 offen lds
    v_mfma_f32_16x16x32_bf16 v[60:63], v[92:95], v[220:223], v[60:63]
    ds_read_b64_tr_b16 v[78:79], v10 offset:50176
    s_setprio 1
    s_waitcnt lgkmcnt(7)
    v_mfma_f32_16x16x32_bf16 v[32:35], v[64:67], v[224:227], v[32:35]
    ds_read_b128 v[232:235], v6 offset:32768
    ds_read_b64_tr_b16 v[80:81], v7 offset:57344
    s_waitcnt lgkmcnt(8)
    v_mfma_f32_16x16x32_bf16 v[36:39], v[64:67], v[228:231], v[36:39]
    ds_read_b64_tr_b16 v[82:83], v7 offset:58368
    s_mov_b32 s100, 233984
    buffer_load_dwordx4 v4, s[48:51], s100 offen offset:1024 lds
    s_waitcnt lgkmcnt(7)
    v_mfma_f32_16x16x32_bf16 v[40:43], v[68:71], v[224:227], v[40:43]
    ds_read_b128 v[236:239], v6 offset:34816
    v_mfma_f32_16x16x32_bf16 v[44:47], v[68:71], v[228:231], v[44:47]
    ds_read_b64_tr_b16 v[84:85], v8 offset:57344
    s_setprio 0
    s_waitcnt lgkmcnt(7)
    v_mfma_f32_16x16x32_bf16 v[48:51], v[72:75], v[224:227], v[48:51]
    ds_read_b64_tr_b16 v[86:87], v8 offset:58368
    ds_read_b64_tr_b16 v[88:89], v9 offset:57344
    v_mfma_f32_16x16x32_bf16 v[52:55], v[72:75], v[228:231], v[52:55]
    ds_read_b64_tr_b16 v[90:91], v9 offset:58368
    s_waitcnt lgkmcnt(8)
    v_mfma_f32_16x16x32_bf16 v[56:59], v[76:79], v[224:227], v[56:59]
    ds_read_b64_tr_b16 v[92:93], v10 offset:57344
    v_mfma_f32_16x16x32_bf16 v[60:63], v[76:79], v[228:231], v[60:63]
    ds_read_b64_tr_b16 v[94:95], v10 offset:58368
    v_add_u32 v5, 0x10000, v5
    v_add_u32 v6, 0x10000, v6
    v_add_u32 v7, 0x10000, v7
    v_add_u32 v8, 0x10000, v8
    v_add_u32 v9, 0x10000, v9
    v_add_u32 v10, 0x10000, v10
    s_waitcnt vmcnt(4)
    s_barrier
    s_setprio 3
    s_waitcnt lgkmcnt(7)
    v_mfma_f32_16x16x32_bf16 v[32:35], v[80:83], v[232:235], v[32:35]
    ds_read_b128 v[240:243], v5 offset:0
    ds_read_b64_tr_b16 v[64:65], v7 offset:16384
    s_add_u32 m0, s10, 32768
    s_mov_b32 s100, 442368
    buffer_load_dwordx4 v4, s[48:51], s100 offen lds
    s_waitcnt lgkmcnt(8)
    v_mfma_f32_16x16x32_bf16 v[36:39], v[80:83], v[236:239], v[36:39]
    ds_read_b64_tr_b16 v[66:67], v7 offset:17408
    s_waitcnt lgkmcnt(7)
    v_mfma_f32_16x16x32_bf16 v[40:43], v[84:87], v[232:235], v[40:43]
    ds_read_b128 v[244:247], v5 offset:2048
    v_mfma_f32_16x16x32_bf16 v[44:47], v[84:87], v[236:239], v[44:47]
    ds_read_b64_tr_b16 v[68:69], v8 offset:16384
    s_mov_b32 s100, 455168
    buffer_load_dwordx4 v4, s[48:51], s100 offen offset:1024 lds
    s_setprio 2
    s_waitcnt lgkmcnt(7)
    v_mfma_f32_16x16x32_bf16 v[48:51], v[88:91], v[232:235], v[48:51]
    ds_read_b64_tr_b16 v[70:71], v8 offset:17408
    ds_read_b64_tr_b16 v[72:73], v9 offset:16384
    v_mfma_f32_16x16x32_bf16 v[52:55], v[88:91], v[236:239], v[52:55]
    ds_read_b64_tr_b16 v[74:75], v9 offset:17408
    s_waitcnt lgkmcnt(8)
    v_mfma_f32_16x16x32_bf16 v[56:59], v[92:95], v[232:235], v[56:59]
    ds_read_b64_tr_b16 v[76:77], v10 offset:16384
    s_add_u32 m0, s10, 49152
    s_mov_b32 s100, 663552
    buffer_load_dwordx4 v4, s[48:51], s100 offen lds
    v_mfma_f32_16x16x32_bf16 v[60:63], v[92:95], v[236:239], v[60:63]
    ds_read_b64_tr_b16 v[78:79], v10 offset:17408
    s_setprio 1
    s_waitcnt lgkmcnt(7)
    v_mfma_f32_16x16x32_bf16 v[32:35], v[64:67], v[240:243], v[32:35]
    ds_read_b128 v[248:251], v6 offset:0
    ds_read_b64_tr_b16 v[80:81], v7 offset:24576
    s_waitcnt lgkmcnt(8)
    v_mfma_f32_16x16x32_bf16 v[36:39], v[64:67], v[244:247], v[36:39]
    ds_read_b64_tr_b16 v[82:83], v7 offset:25600
    s_mov_b32 s100, 676352
    buffer_load_dwordx4 v4, s[48:51], s100 offen offset:1024 lds
    s_waitcnt lgkmcnt(7)
    v_mfma_f32_16x16x32_bf16 v[40:43], v[68:71], v[240:243], v[40:43]
    ds_read_b128 v[252:255], v6 offset:2048
    v_mfma_f32_16x16x32_bf16 v[44:47], v[68:71], v[244:247], v[44:47]
    ds_read_b64_tr_b16 v[84:85], v8 offset:24576
    s_setprio 0
    s_waitcnt lgkmcnt(7)
    v_mfma_f32_16x16x32_bf16 v[48:51], v[72:75], v[240:243], v[48:51]
    ds_read_b64_tr_b16 v[86:87], v8 offset:25600
    ds_read_b64_tr_b16 v[88:89], v9 offset:24576
    v_mfma_f32_16x16x32_bf16 v[52:55], v[72:75], v[244:247], v[52:55]
    ds_read_b64_tr_b16 v[90:91], v9 offset:25600
    s_waitcnt lgkmcnt(8)
    v_mfma_f32_16x16x32_bf16 v[56:59], v[76:79], v[240:243], v[56:59]
    ds_read_b64_tr_b16 v[92:93], v10 offset:24576
    v_mfma_f32_16x16x32_bf16 v[60:63], v[76:79], v[244:247], v[60:63]
    ds_read_b64_tr_b16 v[94:95], v10 offset:25600
    v_xor_b32 v7, 0, v15
    v_xor_b32 v8, 32, v15
    v_xor_b32 v9, 64, v15
    v_xor_b32 v10, 96, v15
    s_waitcnt vmcnt(4)
    s_barrier
    s_setprio 3
    s_waitcnt lgkmcnt(7)
    v_mfma_f32_16x16x32_bf16 v[32:35], v[80:83], v[248:251], v[32:35]
    ds_read_b64_tr_b16 v[64:65], v7 offset:0
    s_add_u32 m0, s10, 65536
    s_mov_b32 s100, 884736
    buffer_load_dwordx4 v4, s[48:51], s100 offen lds
    s_waitcnt lgkmcnt(7)
    v_mfma_f32_16x16x32_bf16 v[36:39], v[80:83], v[252:255], v[36:39]
    ds_read_b64_tr_b16 v[66:67], v7 offset:1024
    s_mov_b32 s100, 897536
    buffer_load_dwordx4 v4, s[48:51], s100 offen offset:1024 lds
    s_waitcnt lgkmcnt(6)
    v_mfma_f32_16x16x32_bf16 v[40:43], v[84:87], v[248:251], v[40:43]
    ds_read_b64_tr_b16 v[68:69], v8 offset:0
    s_add_u32 m0, s10, 81920
    s_mov_b32 s100, 1105920
    buffer_load_dwordx4 v4, s[48:51], s100 offen lds
    v_mfma_f32_16x16x32_bf16 v[44:47], v[84:87], v[252:255], v[44:47]
    ds_read_b64_tr_b16 v[70:71], v8 offset:1024
    s_mov_b32 s100, 1118720
    buffer_load_dwordx4 v4, s[48:51], s100 offen offset:1024 lds
    s_waitcnt lgkmcnt(6)
    v_mfma_f32_16x16x32_bf16 v[48:51], v[88:91], v[248:251], v[48:51]
    ds_read_b64_tr_b16 v[72:73], v9 offset:0
    v_and_b32 v1, 15, v0
    v_lshlrev_b32 v1, 2, v1
    s_lshl_b32 s12, s3, 20
    buffer_load_dword v2, v1, s[76:79], s12 offen sc1
    v_mfma_f32_16x16x32_bf16 v[52:55], v[88:91], v[252:255], v[52:55]
    ds_read_b64_tr_b16 v[74:75], v9 offset:1024
    s_waitcnt lgkmcnt(6)
    v_mfma_f32_16x16x32_bf16 v[56:59], v[92:95], v[248:251], v[56:59]
    ds_read_b64_tr_b16 v[76:77], v10 offset:0
    v_mfma_f32_16x16x32_bf16 v[60:63], v[92:95], v[252:255], v[60:63]
    ds_read_b64_tr_b16 v[78:79], v10 offset:1024
    v_pk_mul_f32 v[32:33], v[32:33], s[84:85] op_sel:[0,1] op_sel_hi:[1,1]
    v_pk_mul_f32 v[34:35], v[34:35], s[84:85] op_sel:[0,1] op_sel_hi:[1,1]
    v_pk_mul_f32 v[36:37], v[36:37], s[84:85] op_sel:[0,1] op_sel_hi:[1,1]
    v_pk_mul_f32 v[38:39], v[38:39], s[84:85] op_sel:[0,1] op_sel_hi:[1,1]
    v_pk_mul_f32 v[40:41], v[40:41], s[84:85] op_sel:[0,1] op_sel_hi:[1,1]
    v_pk_mul_f32 v[42:43], v[42:43], s[84:85] op_sel:[0,1] op_sel_hi:[1,1]
    v_pk_mul_f32 v[44:45], v[44:45], s[84:85] op_sel:[0,1] op_sel_hi:[1,1]
    v_pk_mul_f32 v[46:47], v[46:47], s[84:85] op_sel:[0,1] op_sel_hi:[1,1]
    v_add_u32 v32, s91, v32
    v_add_u32 v36, s91, v36
    v_add_u32 v40, s91, v40
    v_add_u32 v44, s91, v44
    v_and_b32 v32, s92, v32
    v_and_b32 v36, s92, v36
    v_and_b32 v40, s92, v40
    v_and_b32 v44, s92, v44
    v_cvt_pk_bf16_f32 v32, v32, v33
    v_cvt_pk_bf16_f32 v33, v34, v35
    v_cvt_pk_bf16_f32 v34, v40, v41
    v_cvt_pk_bf16_f32 v35, v42, v43
    v_cvt_pk_bf16_f32 v36, v36, v37
    v_cvt_pk_bf16_f32 v37, v38, v39
    v_cvt_pk_bf16_f32 v38, v44, v45
    v_cvt_pk_bf16_f32 v39, v46, v47
    s_mov_b64 exec, s[96:97]
    v_swap_b32 v34, v36
    v_swap_b32 v35, v37
    s_mov_b64 exec, -1
    buffer_store_dwordx4 v[32:35], v11, s[52:55], s88 offen sc1
    v_pk_mul_f32 v[48:49], v[48:49], s[84:85] op_sel:[0,1] op_sel_hi:[1,1]
    v_pk_mul_f32 v[50:51], v[50:51], s[84:85] op_sel:[0,1] op_sel_hi:[1,1]
    v_pk_mul_f32 v[52:53], v[52:53], s[84:85] op_sel:[0,1] op_sel_hi:[1,1]
    v_pk_mul_f32 v[54:55], v[54:55], s[84:85] op_sel:[0,1] op_sel_hi:[1,1]
    v_pk_mul_f32 v[56:57], v[56:57], s[84:85] op_sel:[0,1] op_sel_hi:[1,1]
    v_pk_mul_f32 v[58:59], v[58:59], s[84:85] op_sel:[0,1] op_sel_hi:[1,1]
    v_pk_mul_f32 v[60:61], v[60:61], s[84:85] op_sel:[0,1] op_sel_hi:[1,1]
    v_pk_mul_f32 v[62:63], v[62:63], s[84:85] op_sel:[0,1] op_sel_hi:[1,1]
    v_add_u32 v48, s91, v48
    v_add_u32 v52, s91, v52
    v_add_u32 v56, s91, v56
    v_add_u32 v60, s91, v60
    v_and_b32 v48, s92, v48
    v_and_b32 v52, s92, v52
    v_and_b32 v56, s92, v56
    v_and_b32 v60, s92, v60
    v_cvt_pk_bf16_f32 v40, v48, v49
    v_cvt_pk_bf16_f32 v41, v50, v51
    v_cvt_pk_bf16_f32 v42, v56, v57
    v_cvt_pk_bf16_f32 v43, v58, v59
    v_cvt_pk_bf16_f32 v44, v52, v53
    v_cvt_pk_bf16_f32 v45, v54, v55
    v_cvt_pk_bf16_f32 v46, v60, v61
    v_cvt_pk_bf16_f32 v47, v62, v63
    s_mov_b64 exec, s[98:99]
    v_swap_b32 v42, v44
    v_swap_b32 v43, v45
    s_mov_b64 exec, -1
    s_branch L_p2
    s_endpgm
    s_endpgm
    s_endpgm
    s_endpgm
    s_endpgm
    s_endpgm
    s_endpgm
    s_endpgm
    s_endpgm
    s_endpgm
    s_endpgm
    s_endpgm
    s_endpgm
    s_endpgm
    s_endpgm
    s_endpgm
    s_endpgm
    s_endpgm
    s_endpgm
    s_endpgm
    s_endpgm
    s_endpgm
    s_endpgm
    s_endpgm
    s_endpgm
    s_endpgm
    s_endpgm
    s_endpgm
    s_endpgm
    s_endpgm
    s_endpgm
    s_endpgm
    s_endpgm
    s_endpgm
    s_endpgm
    s_endpgm
    s_endpgm
    s_endpgm
    s_endpgm
    s_endpgm
    s_endpgm
    s_endpgm
    s_endpgm
    s_endpgm
    s_endpgm
    s_endpgm
    s_endpgm
    s_endpgm
    s_endpgm
    s_endpgm
    s_endpgm
    s_endpgm
    s_endpgm
    s_endpgm
    s_endpgm
    s_endpgm
    s_endpgm
    s_endpgm
    s_endpgm
    s_endpgm
    s_endpgm
    s_endpgm
    s_endpgm
    s_endpgm
    s_endpgm
    s_endpgm
    s_endpgm
    s_endpgm
    s_endpgm
    s_endpgm
    s_endpgm
    s_endpgm
    s_endpgm
    s_endpgm
    s_endpgm
    s_endpgm
    s_endpgm
    s_endpgm
    s_endpgm
    s_endpgm
    s_endpgm
    s_endpgm
    s_endpgm
    s_endpgm
    s_endpgm
    s_endpgm
    s_endpgm
    s_endpgm
    s_endpgm
    s_endpgm
    s_endpgm
    s_endpgm
    s_endpgm
    s_endpgm
    s_endpgm
    s_endpgm
    s_endpgm
    s_endpgm
    s_endpgm
    s_endpgm
    s_endpgm
    s_endpgm
    s_endpgm
    s_endpgm
    s_endpgm
    s_endpgm
    s_endpgm
    s_endpgm
    s_endpgm
    s_endpgm
    s_endpgm
    s_endpgm
    s_endpgm
    s_endpgm
    s_endpgm
    s_endpgm
    s_endpgm
    s_endpgm
    s_endpgm
    s_endpgm
    s_endpgm
    s_endpgm
    s_endpgm
    s_endpgm
    s_endpgm
    s_endpgm
    s_endpgm
    s_endpgm
    s_endpgm
    s_endpgm
    s_endpgm
    s_endpgm
    s_endpgm
    s_endpgm
    s_endpgm
    s_endpgm
    s_endpgm
    s_endpgm
    s_endpgm
    s_endpgm
    s_endpgm
    s_endpgm
    s_endpgm
    s_endpgm
    s_endpgm
    s_endpgm
    s_endpgm
    s_endpgm
    s_endpgm
    s_endpgm
    s_endpgm
    s_endpgm
    s_endpgm
    s_endpgm
    s_endpgm
    s_endpgm
    s_endpgm
    s_endpgm
    s_endpgm
    s_endpgm
    s_endpgm
    s_endpgm
    s_endpgm
    s_endpgm
    s_endpgm
    s_endpgm
    s_endpgm
    s_endpgm
    s_endpgm
    s_endpgm
    s_endpgm
    s_endpgm
    s_endpgm
    s_endpgm
    s_endpgm
    s_endpgm
    s_endpgm
    s_endpgm
    s_endpgm
    s_endpgm
    s_endpgm
    s_endpgm
    s_endpgm
    s_endpgm
    s_endpgm
    s_endpgm
    s_endpgm
    s_endpgm
    s_endpgm
    s_endpgm
    s_endpgm
    s_endpgm
    s_endpgm
    s_endpgm
    s_endpgm
    s_endpgm
    s_endpgm
    s_endpgm
    s_endpgm
    s_endpgm
    s_endpgm
    s_endpgm
    s_endpgm
    s_endpgm
    s_endpgm
    s_endpgm
    s_endpgm
    s_endpgm
    s_endpgm
    s_endpgm
    s_endpgm
    s_endpgm
    s_endpgm
    s_endpgm
    s_endpgm
    s_endpgm
    s_endpgm
    s_endpgm
    s_endpgm
    s_endpgm
    s_endpgm
    s_endpgm
    s_endpgm
    s_endpgm
    s_endpgm
    s_endpgm
    s_endpgm
    s_endpgm
    s_endpgm
    s_endpgm
    s_endpgm
    s_endpgm
    s_endpgm
    s_endpgm
    s_endpgm
    s_endpgm
    s_endpgm
    s_endpgm
    s_endpgm
    s_endpgm
    s_endpgm
    s_endpgm
    s_endpgm
    s_endpgm
    s_endpgm
    s_endpgm
    s_endpgm
    s_endpgm
    s_endpgm
    s_endpgm
    s_endpgm
    s_endpgm
    s_endpgm
    s_endpgm
    s_endpgm
    s_endpgm
    s_endpgm
    s_endpgm
    s_endpgm
    s_endpgm
    s_endpgm
    s_endpgm
    s_endpgm
    s_endpgm
    s_endpgm
    s_endpgm
    s_endpgm
    s_endpgm
    s_endpgm
    s_endpgm
    s_endpgm
    s_endpgm
    s_endpgm
    s_endpgm
    s_endpgm
    s_endpgm
    s_endpgm
    s_endpgm
    s_endpgm
    s_endpgm
    s_endpgm
    s_endpgm
    s_endpgm
    s_endpgm
    s_endpgm
    s_endpgm
    s_endpgm
    s_endpgm
    s_endpgm
    s_endpgm
    s_endpgm
    s_endpgm
    s_endpgm
    s_endpgm
    s_endpgm
    s_endpgm
    s_endpgm
    s_endpgm
    s_endpgm
    s_endpgm
    s_endpgm
    s_endpgm
    s_endpgm
    s_endpgm
    s_endpgm
    s_endpgm
    s_endpgm
    s_endpgm
    s_endpgm
    s_endpgm
    s_endpgm
    s_endpgm
    s_endpgm
    s_endpgm
    s_endpgm
    s_endpgm
    s_endpgm
    s_endpgm
    s_endpgm
    s_endpgm
    s_endpgm
    s_endpgm
    s_endpgm
    s_endpgm
    s_endpgm
    s_endpgm
    s_endpgm
    s_endpgm
    s_endpgm
    s_endpgm
    s_endpgm
    s_endpgm
    s_endpgm
    s_endpgm
    s_endpgm
    s_endpgm
    s_endpgm
    s_endpgm
    s_endpgm
    s_endpgm
    s_endpgm
    s_endpgm
    s_endpgm
    s_endpgm
    s_endpgm
    s_endpgm
    s_endpgm
    s_endpgm
    s_endpgm
    s_endpgm
    s_endpgm
    s_endpgm
    s_endpgm
    s_endpgm
    s_endpgm
    s_endpgm
    s_endpgm
    s_endpgm
    s_endpgm
    s_endpgm
    s_endpgm
    s_endpgm
    s_endpgm
    s_endpgm
    s_endpgm
    s_endpgm
    s_endpgm
    s_endpgm
    s_endpgm
    s_endpgm
    s_endpgm
    s_endpgm
    s_endpgm
    s_endpgm
    s_endpgm
    s_endpgm
    s_endpgm
    s_endpgm
    s_endpgm
    s_endpgm
    s_endpgm
    s_endpgm
    s_endpgm
    s_endpgm
    s_endpgm
    s_endpgm
    s_endpgm
    s_endpgm
    s_endpgm
    s_endpgm
    s_endpgm
    s_endpgm
    s_endpgm
    s_endpgm
    s_endpgm
    s_endpgm
    s_endpgm
    s_endpgm
    s_endpgm
    s_endpgm
    s_endpgm
    s_endpgm
    s_endpgm
    s_endpgm
    s_endpgm
    s_endpgm
    s_endpgm
    s_endpgm
    s_endpgm
    s_endpgm
    s_endpgm
    s_endpgm
    s_endpgm
    s_endpgm
    s_endpgm
    s_endpgm
    s_endpgm
    s_endpgm
    s_endpgm
    s_endpgm
    s_endpgm
    s_endpgm
    s_endpgm
    s_endpgm
    s_endpgm
    s_endpgm
    s_endpgm
    s_endpgm
    s_endpgm
    s_endpgm
    s_endpgm
    s_endpgm
    s_endpgm
    s_endpgm
    s_endpgm
    s_endpgm
    s_endpgm
    s_endpgm
    s_endpgm
    s_endpgm
    s_endpgm
    s_endpgm
    s_endpgm
    s_endpgm
    s_endpgm
    s_endpgm
    s_endpgm
    s_endpgm
    s_endpgm
    s_endpgm
    s_endpgm
    s_endpgm
    s_endpgm
    s_endpgm
    s_endpgm
    s_endpgm
    s_endpgm
    s_endpgm
    s_endpgm
    s_endpgm
    s_endpgm
    s_endpgm
    s_endpgm
    s_endpgm
    s_endpgm
    s_endpgm
    s_endpgm
    s_endpgm
    s_endpgm
    s_endpgm
    s_endpgm
    s_endpgm
    s_endpgm
    s_endpgm
    s_endpgm
    s_endpgm
    s_endpgm
    s_endpgm
    s_endpgm
    s_endpgm
    s_endpgm
    s_endpgm
    s_endpgm
    s_endpgm
    s_endpgm
    s_endpgm
    s_endpgm
    s_endpgm
    s_endpgm
    s_endpgm
    s_endpgm
    s_endpgm
    s_endpgm
    s_endpgm
    s_endpgm
    s_endpgm
    s_endpgm
    s_endpgm
    s_endpgm
    s_endpgm
    s_endpgm
    s_endpgm
    s_endpgm
    s_endpgm
    s_endpgm
    s_endpgm
    s_endpgm
    s_endpgm
    s_endpgm
    s_endpgm
    s_endpgm
    s_endpgm
    s_endpgm
    s_endpgm
    s_endpgm
    s_endpgm
    s_endpgm
    s_endpgm
    s_endpgm
    s_endpgm
    s_endpgm
    s_endpgm
    s_endpgm
    s_endpgm
    s_endpgm
    s_endpgm
    s_endpgm
    s_endpgm
    s_endpgm
    s_endpgm
    s_endpgm
    s_endpgm
    s_endpgm
    s_endpgm
    s_endpgm
    s_endpgm
    s_endpgm
    s_endpgm
    s_endpgm
    s_endpgm
    s_endpgm
    s_endpgm
    s_endpgm
    s_endpgm
    s_endpgm
    s_endpgm
    s_endpgm
    s_endpgm
    s_endpgm
    s_endpgm
    s_endpgm
    s_endpgm
    s_endpgm
    s_endpgm
    s_endpgm
    s_endpgm
    s_endpgm
    s_endpgm
    s_endpgm
    s_endpgm
    s_endpgm
    s_endpgm
    s_endpgm
    s_endpgm
    s_endpgm
    s_endpgm
    s_endpgm
    s_endpgm
    s_endpgm
    s_endpgm
    s_endpgm
    s_endpgm
    s_endpgm
    s_endpgm
    s_endpgm
    s_endpgm
    s_endpgm
    s_endpgm
    s_endpgm
    s_endpgm
    s_endpgm
    s_endpgm
    s_endpgm
    s_endpgm
    s_endpgm
    s_endpgm
    s_endpgm
    s_endpgm
    s_endpgm
    s_endpgm
    s_endpgm
    s_endpgm
    s_endpgm
    s_endpgm
    s_endpgm
    s_endpgm
    s_endpgm
    s_endpgm
    s_endpgm
    s_endpgm
    s_endpgm
    s_endpgm
    s_endpgm
    s_endpgm
    s_endpgm
    s_endpgm
    s_endpgm
    s_endpgm
    s_endpgm
    s_endpgm
    s_endpgm
    s_endpgm
    s_endpgm
    s_endpgm
    s_endpgm
    s_endpgm
    s_endpgm
    s_endpgm
    s_endpgm
    s_endpgm
    s_endpgm
    s_endpgm
    s_endpgm
    s_endpgm
    s_endpgm
    s_endpgm
    s_endpgm
    s_endpgm
    s_endpgm
    s_endpgm
    s_endpgm
    s_endpgm
    s_endpgm
    s_endpgm
    s_endpgm
    s_endpgm
    s_endpgm
    s_endpgm
    s_endpgm
    s_endpgm
    s_endpgm
    s_endpgm
    s_endpgm
    s_endpgm
    s_endpgm
    s_endpgm
    s_endpgm
    s_endpgm
    s_endpgm
    s_endpgm
    s_endpgm
    s_endpgm
    s_endpgm
    s_endpgm
    s_endpgm
    s_endpgm
    s_endpgm
    s_endpgm
    s_endpgm
    s_endpgm
    s_endpgm
    s_endpgm
    s_endpgm
    s_endpgm
    s_endpgm
    s_endpgm
    s_endpgm
    s_endpgm
    s_endpgm
    s_endpgm
    s_endpgm
    s_endpgm
    s_endpgm
    s_endpgm
    s_endpgm
    s_endpgm
    s_endpgm
    s_endpgm
    s_endpgm
    s_endpgm
    s_endpgm
    s_endpgm
    s_endpgm
    s_endpgm
    s_endpgm
    s_endpgm
    s_endpgm
    s_endpgm
    s_endpgm
    s_endpgm
    s_endpgm
    s_endpgm
    s_endpgm
    s_endpgm
    s_endpgm
    s_endpgm
    s_endpgm
    s_endpgm
    s_endpgm
    s_endpgm
    s_endpgm
    s_endpgm
    s_endpgm
    s_endpgm
    s_endpgm
    s_endpgm
    s_endpgm
    s_endpgm
    s_endpgm
    s_endpgm
    s_endpgm
    s_endpgm
    s_endpgm
    s_endpgm
    s_endpgm
    s_endpgm
    s_endpgm
    s_endpgm
    s_endpgm
    s_endpgm
    s_endpgm
    s_endpgm
    s_endpgm
    s_endpgm
    s_endpgm
    s_endpgm
    s_endpgm
    s_endpgm
    s_endpgm
    s_endpgm
    s_endpgm
    s_endpgm
    s_endpgm
    s_endpgm
    s_endpgm
    s_endpgm
    s_endpgm
    s_endpgm
    s_endpgm
    s_endpgm
    s_endpgm
    s_endpgm
    s_endpgm
    s_endpgm
    s_endpgm
    s_endpgm
    s_endpgm
    s_endpgm
    s_endpgm
    s_endpgm
    s_endpgm
    s_endpgm
    s_endpgm
    s_endpgm
    s_endpgm
    s_endpgm
    s_endpgm
    s_endpgm
    s_endpgm
    s_endpgm
    s_endpgm
    s_endpgm
    s_endpgm
    s_endpgm
    s_endpgm
    s_endpgm
    s_endpgm
    s_endpgm
    s_endpgm
    s_endpgm
    s_endpgm
    s_endpgm
    s_endpgm
    s_endpgm
    s_endpgm
    s_endpgm
    s_endpgm
    s_endpgm
    s_endpgm
    s_endpgm
    s_endpgm
    s_endpgm
    s_endpgm
    s_endpgm
    s_endpgm
    s_endpgm
    s_endpgm
    s_endpgm
    s_endpgm
    s_endpgm
    s_endpgm
    s_endpgm
    s_endpgm
    s_endpgm
    s_endpgm
    s_endpgm
    s_endpgm
    s_endpgm
    s_endpgm
    s_endpgm
    s_endpgm
    s_endpgm
    s_endpgm
    s_endpgm
    s_endpgm
    s_endpgm
    s_endpgm
    s_endpgm
    s_endpgm
    s_endpgm
    s_endpgm
    s_endpgm
    s_endpgm
    s_endpgm
    s_endpgm
    s_endpgm
    s_endpgm
    s_endpgm
    s_endpgm
    s_endpgm
    s_endpgm
    s_endpgm
    s_endpgm
    s_endpgm
    s_endpgm
    s_endpgm
    s_endpgm
    s_endpgm
    s_endpgm
    s_endpgm
    s_endpgm
    s_endpgm
    s_endpgm
    s_endpgm
    s_endpgm
    s_endpgm
    s_endpgm
    s_endpgm
    s_endpgm
    s_endpgm
    s_endpgm
    s_endpgm
    s_endpgm
    s_endpgm
    s_endpgm
    s_endpgm
    s_endpgm
    s_endpgm
    s_endpgm
    s_endpgm
    s_endpgm
    s_endpgm
    s_endpgm
    s_endpgm
    s_endpgm
    s_endpgm
    s_endpgm
    s_endpgm
    s_endpgm
    s_endpgm
    s_endpgm
    s_endpgm
    s_endpgm
    s_endpgm
    s_endpgm
    s_endpgm
    s_endpgm
    s_endpgm
    s_endpgm
    s_endpgm
    s_endpgm
    s_endpgm
    s_endpgm
    s_endpgm
    s_endpgm
    s_endpgm
    s_endpgm
    s_endpgm
    s_endpgm
    s_endpgm
    s_endpgm
    s_endpgm
    s_endpgm
    s_endpgm
    s_endpgm
    s_endpgm
    s_endpgm
    s_endpgm
    s_endpgm
    s_endpgm
    s_endpgm
    s_endpgm
    s_endpgm
    s_endpgm
    s_endpgm
    s_endpgm
    s_endpgm
    s_endpgm
    s_endpgm
    s_endpgm
    s_endpgm
    s_endpgm
    s_endpgm
    s_endpgm
    s_endpgm
    s_endpgm
    s_endpgm
    s_endpgm
    s_endpgm
    s_endpgm
    s_endpgm
    s_endpgm
    s_endpgm
    s_endpgm
    s_endpgm
    s_endpgm
    s_endpgm
    s_endpgm
    s_endpgm
    s_endpgm
    s_endpgm
    s_endpgm
    s_endpgm
    s_endpgm
    s_endpgm
    s_endpgm
    s_endpgm
    s_endpgm
    s_endpgm
    s_endpgm
    s_endpgm
    s_endpgm
    s_endpgm
    s_endpgm
    s_endpgm
    s_endpgm
    s_endpgm
    s_endpgm
    s_endpgm
    s_endpgm
    s_endpgm
    s_endpgm
    s_endpgm
    s_endpgm
    s_endpgm
    s_endpgm
    s_endpgm
    s_endpgm
L_p1v:
    v_mov_b32 v7, v15
    v_xor_b32 v8, 32, v7
    v_xor_b32 v9, 64, v7
    v_xor_b32 v10, 96, v7
    s_lshl1_add_u32 s12, s94, s9
    s_lshl_b32 s12, s12, 6
    s_mov_b32 s13, 163520
    v_mul_u32_u24 v226, 320, v241
    s_mul_i32 s14, s84, 2560
    s_add_u32 s88, s14, 2688256
    v_add3_u32 v224, v240, s12, 0
    v_mul_u32_u24 v225, 3277, v224
    v_lshrrev_b32 v225, 16, v225
    v_lshl_add_u32 v224, v224, 4, v226
    v_mad_u32_u24 v11, v225, s13, v224
    v_add3_u32 v224, v240, s12, 16
    v_mul_u32_u24 v225, 3277, v224
    v_lshrrev_b32 v225, 16, v225
    v_lshl_add_u32 v224, v224, 4, v226
    v_mad_u32_u24 v12, v225, s13, v224
    v_add3_u32 v224, v240, s12, 32
    v_mul_u32_u24 v225, 3277, v224
    v_lshrrev_b32 v225, 16, v225
    v_lshl_add_u32 v224, v224, 4, v226
    v_mad_u32_u24 v13, v225, s13, v224
    v_add3_u32 v224, v240, s12, 48
    v_mul_u32_u24 v225, 3277, v224
    v_lshrrev_b32 v225, 16, v225
    v_lshl_add_u32 v224, v224, 4, v226
    v_mad_u32_u24 v14, v225, s13, v224
    s_add_u32 m0, s10, 0
    s_mov_b32 s100, 0
    buffer_load_dwordx4 v1, s[40:43], s100 offen lds
    buffer_load_dwordx4 v2, s[40:43], s100 offen offset:1024 lds
    s_add_u32 m0, s10, 16384
    s_mov_b32 s100, 0
    buffer_load_dwordx4 v3, s[44:47], s100 offen lds
    s_mov_b32 s100, 14336
    buffer_load_dwordx4 v3, s[44:47], s100 offen offset:1024 lds
    s_barrier
    s_add_u32 m0, s10, 32768
    s_mov_b32 s100, 128
    buffer_load_dwordx4 v1, s[40:43], s100 offen lds
    buffer_load_dwordx4 v2, s[40:43], s100 offen offset:1024 lds
    s_add_u32 m0, s10, 49152
    s_mov_b32 s100, 245760
    buffer_load_dwordx4 v3, s[44:47], s100 offen lds
    s_mov_b32 s100, 260096
    buffer_load_dwordx4 v3, s[44:47], s100 offen offset:1024 lds
    s_waitcnt vmcnt(4)
    s_barrier
    ds_read_b128 v[96:99], v5 offset:0
    ds_read_b64_tr_b16 v[64:65], v7 offset:16384
    ds_read_b64_tr_b16 v[66:67], v7 offset:17408
    ds_read_b128 v[100:103], v5 offset:2048
    ds_read_b64_tr_b16 v[68:69], v8 offset:16384
    ds_read_b64_tr_b16 v[70:71], v8 offset:17408
    ds_read_b64_tr_b16 v[72:73], v9 offset:16384
    ds_read_b64_tr_b16 v[74:75], v9 offset:17408
    ds_read_b64_tr_b16 v[76:77], v10 offset:16384
    ds_read_b64_tr_b16 v[78:79], v10 offset:17408
    s_setprio 1
    s_waitcnt lgkmcnt(7)
    v_mfma_f32_16x16x32_bf16 v[32:35], v[96:99], v[64:67], 0
    ds_read_b128 v[104:107], v6 offset:0
    ds_read_b64_tr_b16 v[80:81], v7 offset:24576
    s_add_u32 m0, s10, 65536
    s_mov_b32 s100, 256
    buffer_load_dwordx4 v1, s[40:43], s100 offen lds
    s_waitcnt lgkmcnt(8)
    v_mfma_f32_16x16x32_bf16 v[36:39], v[100:103], v[64:67], 0
    ds_read_b64_tr_b16 v[82:83], v7 offset:25600
    s_waitcnt lgkmcnt(7)
    v_mfma_f32_16x16x32_bf16 v[40:43], v[96:99], v[68:71], 0
    ds_read_b128 v[108:111], v6 offset:2048
    buffer_load_dwordx4 v2, s[40:43], s100 offen offset:1024 lds
    v_mfma_f32_16x16x32_bf16 v[44:47], v[100:103], v[68:71], 0
    ds_read_b64_tr_b16 v[84:85], v8 offset:24576
    s_setprio 0
    s_waitcnt lgkmcnt(7)
    v_mfma_f32_16x16x32_bf16 v[48:51], v[96:99], v[72:75], 0
    ds_read_b64_tr_b16 v[86:87], v8 offset:25600
    ds_read_b64_tr_b16 v[88:89], v9 offset:24576
    s_add_u32 m0, s10, 81920
    s_mov_b32 s100, 491520
    buffer_load_dwordx4 v3, s[44:47], s100 offen lds
    v_mfma_f32_16x16x32_bf16 v[52:55], v[100:103], v[72:75], 0
    ds_read_b64_tr_b16 v[90:91], v9 offset:25600
    s_waitcnt lgkmcnt(8)
    v_mfma_f32_16x16x32_bf16 v[56:59], v[96:99], v[76:79], 0
    ds_read_b64_tr_b16 v[92:93], v10 offset:24576
    s_mov_b32 s100, 505856
    buffer_load_dwordx4 v3, s[44:47], s100 offen offset:1024 lds
    v_mfma_f32_16x16x32_bf16 v[60:63], v[100:103], v[76:79], 0
    ds_read_b64_tr_b16 v[94:95], v10 offset:25600
    s_waitcnt vmcnt(4)
    s_barrier
    s_setprio 3
    s_waitcnt lgkmcnt(7)
    v_mfma_f32_16x16x32_bf16 v[32:35], v[104:107], v[80:83], v[32:35]
    ds_read_b128 v[112:115], v5 offset:32768
    ds_read_b64_tr_b16 v[64:65], v7 offset:49152
    s_add_u32 m0, s10, 98304
    s_mov_b32 s100, 384
    buffer_load_dwordx4 v1, s[40:43], s100 offen lds
    s_waitcnt lgkmcnt(8)
    v_mfma_f32_16x16x32_bf16 v[36:39], v[108:111], v[80:83], v[36:39]
    ds_read_b64_tr_b16 v[66:67], v7 offset:50176
    s_waitcnt lgkmcnt(7)
    v_mfma_f32_16x16x32_bf16 v[40:43], v[104:107], v[84:87], v[40:43]
    ds_read_b128 v[116:119], v5 offset:34816
    v_mfma_f32_16x16x32_bf16 v[44:47], v[108:111], v[84:87], v[44:47]
    ds_read_b64_tr_b16 v[68:69], v8 offset:49152
    buffer_load_dwordx4 v2, s[40:43], s100 offen offset:1024 lds
    s_setprio 2
    s_waitcnt lgkmcnt(7)
    v_mfma_f32_16x16x32_bf16 v[48:51], v[104:107], v[88:91], v[48:51]
    ds_read_b64_tr_b16 v[70:71], v8 offset:50176
    ds_read_b64_tr_b16 v[72:73], v9 offset:49152
    v_mfma_f32_16x16x32_bf16 v[52:55], v[108:111], v[88:91], v[52:55]
    ds_read_b64_tr_b16 v[74:75], v9 offset:50176
    s_waitcnt lgkmcnt(8)
    v_mfma_f32_16x16x32_bf16 v[56:59], v[104:107], v[92:95], v[56:59]
    ds_read_b64_tr_b16 v[76:77], v10 offset:49152
    s_add_u32 m0, s10, 114688
    s_mov_b32 s100, 737280
    buffer_load_dwordx4 v3, s[44:47], s100 offen lds
    v_mfma_f32_16x16x32_bf16 v[60:63], v[108:111], v[92:95], v[60:63]
    ds_read_b64_tr_b16 v[78:79], v10 offset:50176
    s_setprio 1
    s_waitcnt lgkmcnt(7)
    v_mfma_f32_16x16x32_bf16 v[32:35], v[112:115], v[64:67], v[32:35]
    ds_read_b128 v[120:123], v6 offset:32768
    ds_read_b64_tr_b16 v[80:81], v7 offset:57344
    s_waitcnt lgkmcnt(8)
    v_mfma_f32_16x16x32_bf16 v[36:39], v[116:119], v[64:67], v[36:39]
    ds_read_b64_tr_b16 v[82:83], v7 offset:58368
    s_mov_b32 s100, 751616
    buffer_load_dwordx4 v3, s[44:47], s100 offen offset:1024 lds
    s_waitcnt lgkmcnt(7)
    v_mfma_f32_16x16x32_bf16 v[40:43], v[112:115], v[68:71], v[40:43]
    ds_read_b128 v[124:127], v6 offset:34816
    v_mfma_f32_16x16x32_bf16 v[44:47], v[116:119], v[68:71], v[44:47]
    ds_read_b64_tr_b16 v[84:85], v8 offset:57344
    s_setprio 0
    s_waitcnt lgkmcnt(7)
    v_mfma_f32_16x16x32_bf16 v[48:51], v[112:115], v[72:75], v[48:51]
    ds_read_b64_tr_b16 v[86:87], v8 offset:58368
    ds_read_b64_tr_b16 v[88:89], v9 offset:57344
    v_mfma_f32_16x16x32_bf16 v[52:55], v[116:119], v[72:75], v[52:55]
    ds_read_b64_tr_b16 v[90:91], v9 offset:58368
    s_waitcnt lgkmcnt(8)
    v_mfma_f32_16x16x32_bf16 v[56:59], v[112:115], v[76:79], v[56:59]
    ds_read_b64_tr_b16 v[92:93], v10 offset:57344
    v_mfma_f32_16x16x32_bf16 v[60:63], v[116:119], v[76:79], v[60:63]
    ds_read_b64_tr_b16 v[94:95], v10 offset:58368
    v_add_u32 v5, 0x10000, v5
    v_add_u32 v6, 0x10000, v6
    v_add_u32 v7, 0x10000, v7
    v_add_u32 v8, 0x10000, v8
    v_add_u32 v9, 0x10000, v9
    v_add_u32 v10, 0x10000, v10
    s_waitcnt vmcnt(4)
    s_barrier
    s_lshl3_add_u32 s15, s2, s3
    s_mul_i32 s100, s15, 1152
    s_mov_b64 exec, 0x1ff
    buffer_load_dword v251, v254, s[48:51], s100 offen
    s_lshl_b32 s100, s15, 8
    s_add_u32 s100, s100, 327680
    s_mov_b64 exec, 3
    buffer_load_dword v252, v254, s[56:59], s100 offen
    s_mov_b64 exec, -1
    s_setprio 3
    s_waitcnt lgkmcnt(7)
    v_mfma_f32_16x16x32_bf16 v[32:35], v[120:123], v[80:83], v[32:35]
    ds_read_b128 v[128:131], v5 offset:0
    ds_read_b64_tr_b16 v[64:65], v7 offset:16384
    s_add_u32 m0, s10, 131072
    s_mov_b32 s100, 512
    buffer_load_dwordx4 v1, s[40:43], s100 offen lds
    s_waitcnt lgkmcnt(8)
    v_mfma_f32_16x16x32_bf16 v[36:39], v[124:127], v[80:83], v[36:39]
    ds_read_b64_tr_b16 v[66:67], v7 offset:17408
    s_waitcnt lgkmcnt(7)
    v_mfma_f32_16x16x32_bf16 v[40:43], v[120:123], v[84:87], v[40:43]
    ds_read_b128 v[132:135], v5 offset:2048
    v_mfma_f32_16x16x32_bf16 v[44:47], v[124:127], v[84:87], v[44:47]
    ds_read_b64_tr_b16 v[68:69], v8 offset:16384
    buffer_load_dwordx4 v2, s[40:43], s100 offen offset:1024 lds
    s_setprio 2
    s_waitcnt lgkmcnt(7)
    v_mfma_f32_16x16x32_bf16 v[48:51], v[120:123], v[88:91], v[48:51]
    ds_read_b64_tr_b16 v[70:71], v8 offset:17408
    ds_read_b64_tr_b16 v[72:73], v9 offset:16384
    v_mfma_f32_16x16x32_bf16 v[52:55], v[124:127], v[88:91], v[52:55]
    ds_read_b64_tr_b16 v[74:75], v9 offset:17408
    s_waitcnt lgkmcnt(8)
    v_mfma_f32_16x16x32_bf16 v[56:59], v[120:123], v[92:95], v[56:59]
    ds_read_b64_tr_b16 v[76:77], v10 offset:16384
    s_add_u32 m0, s10, 147456
    s_mov_b32 s100, 983040
    buffer_load_dwordx4 v3, s[44:47], s100 offen lds
    v_mfma_f32_16x16x32_bf16 v[60:63], v[124:127], v[92:95], v[60:63]
    ds_read_b64_tr_b16 v[78:79], v10 offset:17408
    s_setprio 1
    s_waitcnt lgkmcnt(7)
    v_mfma_f32_16x16x32_bf16 v[32:35], v[128:131], v[64:67], v[32:35]
    ds_read_b128 v[136:139], v6 offset:0
    ds_read_b64_tr_b16 v[80:81], v7 offset:24576
    s_waitcnt lgkmcnt(8)
    v_mfma_f32_16x16x32_bf16 v[36:39], v[132:135], v[64:67], v[36:39]
    ds_read_b64_tr_b16 v[82:83], v7 offset:25600
    s_mov_b32 s100, 997376
    buffer_load_dwordx4 v3, s[44:47], s100 offen offset:1024 lds
    s_waitcnt lgkmcnt(7)
    v_mfma_f32_16x16x32_bf16 v[40:43], v[128:131], v[68:71], v[40:43]
    ds_read_b128 v[140:143], v6 offset:2048
    v_mfma_f32_16x16x32_bf16 v[44:47], v[132:135], v[68:71], v[44:47]
    ds_read_b64_tr_b16 v[84:85], v8 offset:24576
    s_setprio 0
    s_waitcnt lgkmcnt(7)
    v_mfma_f32_16x16x32_bf16 v[48:51], v[128:131], v[72:75], v[48:51]
    ds_read_b64_tr_b16 v[86:87], v8 offset:25600
    ds_read_b64_tr_b16 v[88:89], v9 offset:24576
    v_mfma_f32_16x16x32_bf16 v[52:55], v[132:135], v[72:75], v[52:55]
    ds_read_b64_tr_b16 v[90:91], v9 offset:25600
    s_waitcnt lgkmcnt(8)
    v_mfma_f32_16x16x32_bf16 v[56:59], v[128:131], v[76:79], v[56:59]
    ds_read_b64_tr_b16 v[92:93], v10 offset:24576
    v_mfma_f32_16x16x32_bf16 v[60:63], v[132:135], v[76:79], v[60:63]
    ds_read_b64_tr_b16 v[94:95], v10 offset:25600
    s_waitcnt vmcnt(6)
    s_barrier
    s_setprio 3
    s_waitcnt lgkmcnt(7)
    v_mfma_f32_16x16x32_bf16 v[32:35], v[136:139], v[80:83], v[32:35]
    ds_read_b128 v[144:147], v5 offset:32768
    ds_read_b64_tr_b16 v[64:65], v7 offset:49152
    s_add_u32 m0, s10, 0
    s_mov_b32 s100, 640
    buffer_load_dwordx4 v1, s[40:43], s100 offen lds
    s_waitcnt lgkmcnt(8)
    v_mfma_f32_16x16x32_bf16 v[36:39], v[140:143], v[80:83], v[36:39]
    ds_read_b64_tr_b16 v[66:67], v7 offset:50176
    v_lshlrev_b32 v16, 16, v18
    s_waitcnt lgkmcnt(7)
    v_mfma_f32_16x16x32_bf16 v[40:43], v[136:139], v[84:87], v[40:43]
    ds_read_b128 v[148:151], v5 offset:34816
    v_mfma_f32_16x16x32_bf16 v[44:47], v[140:143], v[84:87], v[44:47]
    ds_read_b64_tr_b16 v[68:69], v8 offset:49152
    buffer_load_dwordx4 v2, s[40:43], s100 offen offset:1024 lds
    s_setprio 2
    s_waitcnt lgkmcnt(7)
    v_mfma_f32_16x16x32_bf16 v[48:51], v[136:139], v[88:91], v[48:51]
    ds_read_b64_tr_b16 v[70:71], v8 offset:50176
    ds_read_b64_tr_b16 v[72:73], v9 offset:49152
    v_and_b32 v17, 0xffff0000, v18
    v_mfma_f32_16x16x32_bf16 v[52:55], v[140:143], v[88:91], v[52:55]
    ds_read_b64_tr_b16 v[74:75], v9 offset:50176
    s_waitcnt lgkmcnt(8)
    v_mfma_f32_16x16x32_bf16 v[56:59], v[136:139], v[92:95], v[56:59]
    ds_read_b64_tr_b16 v[76:77], v10 offset:49152
    s_add_u32 m0, s10, 16384
    s_mov_b32 s100, 1228800
    buffer_load_dwordx4 v3, s[44:47], s100 offen lds
    v_mfma_f32_16x16x32_bf16 v[60:63], v[140:143], v[92:95], v[60:63]
    ds_read_b64_tr_b16 v[78:79], v10 offset:50176
    v_lshlrev_b32 v18, 16, v19
    s_setprio 1
    s_waitcnt lgkmcnt(7)
    v_mfma_f32_16x16x32_bf16 v[32:35], v[144:147], v[64:67], v[32:35]
    ds_read_b128 v[152:155], v6 offset:32768
    ds_read_b64_tr_b16 v[80:81], v7 offset:57344
    s_waitcnt lgkmcnt(8)
    v_mfma_f32_16x16x32_bf16 v[36:39], v[148:151], v[64:67], v[36:39]
    ds_read_b64_tr_b16 v[82:83], v7 offset:58368
    s_mov_b32 s100, 1243136
    buffer_load_dwordx4 v3, s[44:47], s100 offen offset:1024 lds
    s_waitcnt lgkmcnt(7)
    v_mfma_f32_16x16x32_bf16 v[40:43], v[144:147], v[68:71], v[40:43]
    ds_read_b128 v[156:159], v6 offset:34816
    v_and_b32 v19, 0xffff0000, v19
    v_mfma_f32_16x16x32_bf16 v[44:47], v[148:151], v[68:71], v[44:47]
    ds_read_b64_tr_b16 v[84:85], v8 offset:57344
    s_setprio 0
    s_waitcnt lgkmcnt(7)
    v_mfma_f32_16x16x32_bf16 v[48:51], v[144:147], v[72:75], v[48:51]
    ds_read_b64_tr_b16 v[86:87], v8 offset:58368
    ds_read_b64_tr_b16 v[88:89], v9 offset:57344
    v_mfma_f32_16x16x32_bf16 v[52:55], v[148:151], v[72:75], v[52:55]
    ds_read_b64_tr_b16 v[90:91], v9 offset:58368
    s_waitcnt lgkmcnt(8)
    v_mfma_f32_16x16x32_bf16 v[56:59], v[144:147], v[76:79], v[56:59]
    ds_read_b64_tr_b16 v[92:93], v10 offset:57344
    v_mfma_f32_16x16x32_bf16 v[60:63], v[148:151], v[76:79], v[60:63]
    ds_read_b64_tr_b16 v[94:95], v10 offset:58368
    v_add_u32 v5, 0x10000, v5
    v_add_u32 v6, 0x10000, v6
    v_add_u32 v7, 0x10000, v7
    v_add_u32 v8, 0x10000, v8
    v_add_u32 v9, 0x10000, v9
    v_add_u32 v10, 0x10000, v10
    s_waitcnt vmcnt(4)
    s_barrier
    s_setprio 3
    s_waitcnt lgkmcnt(7)
    v_mfma_f32_16x16x32_bf16 v[32:35], v[152:155], v[80:83], v[32:35]
    ds_read_b128 v[160:163], v5 offset:0
    ds_read_b64_tr_b16 v[64:65], v7 offset:16384
    s_add_u32 m0, s10, 32768
    s_mov_b32 s100, 768
    buffer_load_dwordx4 v1, s[40:43], s100 offen lds
    s_waitcnt lgkmcnt(8)
    v_mfma_f32_16x16x32_bf16 v[36:39], v[156:159], v[80:83], v[36:39]
    ds_read_b64_tr_b16 v[66:67], v7 offset:17408
    v_lshlrev_b32 v20, 16, v22
    s_waitcnt lgkmcnt(7)
    v_mfma_f32_16x16x32_bf16 v[40:43], v[152:155], v[84:87], v[40:43]
    ds_read_b128 v[164:167], v5 offset:2048
    v_mfma_f32_16x16x32_bf16 v[44:47], v[156:159], v[84:87], v[44:47]
    ds_read_b64_tr_b16 v[68:69], v8 offset:16384
    buffer_load_dwordx4 v2, s[40:43], s100 offen offset:1024 lds
    s_setprio 2
    s_waitcnt lgkmcnt(7)
    v_mfma_f32_16x16x32_bf16 v[48:51], v[152:155], v[88:91], v[48:51]
    ds_read_b64_tr_b16 v[70:71], v8 offset:17408
    ds_read_b64_tr_b16 v[72:73], v9 offset:16384
    v_and_b32 v21, 0xffff0000, v22
    v_mfma_f32_16x16x32_bf16 v[52:55], v[156:159], v[88:91], v[52:55]
    ds_read_b64_tr_b16 v[74:75], v9 offset:17408
    s_waitcnt lgkmcnt(8)
    v_mfma_f32_16x16x32_bf16 v[56:59], v[152:155], v[92:95], v[56:59]
    ds_read_b64_tr_b16 v[76:77], v10 offset:16384
    s_add_u32 m0, s10, 49152
    s_mov_b32 s100, 1474560
    buffer_load_dwordx4 v3, s[44:47], s100 offen lds
    v_mfma_f32_16x16x32_bf16 v[60:63], v[156:159], v[92:95], v[60:63]
    ds_read_b64_tr_b16 v[78:79], v10 offset:17408
    v_lshlrev_b32 v22, 16, v23
    s_setprio 1
    s_waitcnt lgkmcnt(7)
    v_mfma_f32_16x16x32_bf16 v[32:35], v[160:163], v[64:67], v[32:35]
    ds_read_b128 v[168:171], v6 offset:0
    ds_read_b64_tr_b16 v[80:81], v7 offset:24576
    s_waitcnt lgkmcnt(8)
    v_mfma_f32_16x16x32_bf16 v[36:39], v[164:167], v[64:67], v[36:39]
    ds_read_b64_tr_b16 v[82:83], v7 offset:25600
    s_mov_b32 s100, 1488896
    buffer_load_dwordx4 v3, s[44:47], s100 offen offset:1024 lds
    s_waitcnt lgkmcnt(7)
    v_mfma_f32_16x16x32_bf16 v[40:43], v[160:163], v[68:71], v[40:43]
    ds_read_b128 v[172:175], v6 offset:2048
    v_and_b32 v23, 0xffff0000, v23
    v_mfma_f32_16x16x32_bf16 v[44:47], v[164:167], v[68:71], v[44:47]
    ds_read_b64_tr_b16 v[84:85], v8 offset:24576
    s_setprio 0
    s_waitcnt lgkmcnt(7)
    v_mfma_f32_16x16x32_bf16 v[48:51], v[160:163], v[72:75], v[48:51]
    ds_read_b64_tr_b16 v[86:87], v8 offset:25600
    ds_read_b64_tr_b16 v[88:89], v9 offset:24576
    v_mfma_f32_16x16x32_bf16 v[52:55], v[164:167], v[72:75], v[52:55]
    ds_read_b64_tr_b16 v[90:91], v9 offset:25600
    s_waitcnt lgkmcnt(8)
    v_mfma_f32_16x16x32_bf16 v[56:59], v[160:163], v[76:79], v[56:59]
    ds_read_b64_tr_b16 v[92:93], v10 offset:24576
    v_mfma_f32_16x16x32_bf16 v[60:63], v[164:167], v[76:79], v[60:63]
    ds_read_b64_tr_b16 v[94:95], v10 offset:25600
    v_add_u32 v5, 0xfffe0000, v5
    v_add_u32 v6, 0xfffe0000, v6
    v_add_u32 v7, 0xfffe0000, v7
    v_add_u32 v8, 0xfffe0000, v8
    v_add_u32 v9, 0xfffe0000, v9
    v_add_u32 v10, 0xfffe0000, v10
    s_waitcnt vmcnt(4)
    s_barrier
    s_setprio 3
    s_waitcnt lgkmcnt(7)
    v_mfma_f32_16x16x32_bf16 v[32:35], v[168:171], v[80:83], v[32:35]
    ds_read_b128 v[176:179], v5 offset:0
    ds_read_b64_tr_b16 v[64:65], v7 offset:16384
    s_add_u32 m0, s10, 65536
    s_mov_b32 s100, 896
    buffer_load_dwordx4 v1, s[40:43], s100 offen lds
    s_waitcnt lgkmcnt(8)
    v_mfma_f32_16x16x32_bf16 v[36:39], v[172:175], v[80:83], v[36:39]
    ds_read_b64_tr_b16 v[66:67], v7 offset:17408
    v_lshlrev_b32 v24, 16, v26
    s_waitcnt lgkmcnt(7)
    v_mfma_f32_16x16x32_bf16 v[40:43], v[168:171], v[84:87], v[40:43]
    ds_read_b128 v[180:183], v5 offset:2048
    v_mfma_f32_16x16x32_bf16 v[44:47], v[172:175], v[84:87], v[44:47]
    ds_read_b64_tr_b16 v[68:69], v8 offset:16384
    buffer_load_dwordx4 v2, s[40:43], s100 offen offset:1024 lds
    s_setprio 2
    s_waitcnt lgkmcnt(7)
    v_mfma_f32_16x16x32_bf16 v[48:51], v[168:171], v[88:91], v[48:51]
    ds_read_b64_tr_b16 v[70:71], v8 offset:17408
    ds_read_b64_tr_b16 v[72:73], v9 offset:16384
    v_and_b32 v25, 0xffff0000, v26
    v_mfma_f32_16x16x32_bf16 v[52:55], v[172:175], v[88:91], v[52:55]
    ds_read_b64_tr_b16 v[74:75], v9 offset:17408
    s_waitcnt lgkmcnt(8)
    v_mfma_f32_16x16x32_bf16 v[56:59], v[168:171], v[92:95], v[56:59]
    ds_read_b64_tr_b16 v[76:77], v10 offset:16384
    s_add_u32 m0, s10, 81920
    s_mov_b32 s100, 1720320
    buffer_load_dwordx4 v3, s[44:47], s100 offen lds
    v_mfma_f32_16x16x32_bf16 v[60:63], v[172:175], v[92:95], v[60:63]
    ds_read_b64_tr_b16 v[78:79], v10 offset:17408
    v_lshlrev_b32 v26, 16, v27
    s_setprio 1
    s_waitcnt lgkmcnt(7)
    v_mfma_f32_16x16x32_bf16 v[32:35], v[176:179], v[64:67], v[32:35]
    ds_read_b128 v[184:187], v6 offset:0
    ds_read_b64_tr_b16 v[80:81], v7 offset:24576
    s_waitcnt lgkmcnt(8)
    v_mfma_f32_16x16x32_bf16 v[36:39], v[180:183], v[64:67], v[36:39]
    ds_read_b64_tr_b16 v[82:83], v7 offset:25600
    s_mov_b32 s100, 1734656
    buffer_load_dwordx4 v3, s[44:47], s100 offen offset:1024 lds
    s_waitcnt lgkmcnt(7)
    v_mfma_f32_16x16x32_bf16 v[40:43], v[176:179], v[68:71], v[40:43]
    ds_read_b128 v[188:191], v6 offset:2048
    v_and_b32 v27, 0xffff0000, v27
    v_mfma_f32_16x16x32_bf16 v[44:47], v[180:183], v[68:71], v[44:47]
    ds_read_b64_tr_b16 v[84:85], v8 offset:24576
    s_setprio 0
    s_waitcnt lgkmcnt(7)
    v_mfma_f32_16x16x32_bf16 v[48:51], v[176:179], v[72:75], v[48:51]
    ds_read_b64_tr_b16 v[86:87], v8 offset:25600
    ds_read_b64_tr_b16 v[88:89], v9 offset:24576
    v_mfma_f32_16x16x32_bf16 v[52:55], v[180:183], v[72:75], v[52:55]
    ds_read_b64_tr_b16 v[90:91], v9 offset:25600
    s_waitcnt lgkmcnt(8)
    v_mfma_f32_16x16x32_bf16 v[56:59], v[176:179], v[76:79], v[56:59]
    ds_read_b64_tr_b16 v[92:93], v10 offset:24576
    v_mfma_f32_16x16x32_bf16 v[60:63], v[180:183], v[76:79], v[60:63]
    ds_read_b64_tr_b16 v[94:95], v10 offset:25600
    s_waitcnt vmcnt(4)
    s_barrier
    s_setprio 3
    s_waitcnt lgkmcnt(7)
    v_mfma_f32_16x16x32_bf16 v[32:35], v[184:187], v[80:83], v[32:35]
    ds_read_b128 v[192:195], v5 offset:32768
    ds_read_b64_tr_b16 v[64:65], v7 offset:49152
    s_add_u32 m0, s10, 98304
    s_mov_b32 s100, 1024
    buffer_load_dwordx4 v1, s[40:43], s100 offen lds
    s_waitcnt lgkmcnt(8)
    v_mfma_f32_16x16x32_bf16 v[36:39], v[188:191], v[80:83], v[36:39]
    ds_read_b64_tr_b16 v[66:67], v7 offset:50176
    v_lshlrev_b32 v28, 16, v30
    s_waitcnt lgkmcnt(7)
    v_mfma_f32_16x16x32_bf16 v[40:43], v[184:187], v[84:87], v[40:43]
    ds_read_b128 v[196:199], v5 offset:34816
    v_mfma_f32_16x16x32_bf16 v[44:47], v[188:191], v[84:87], v[44:47]
    ds_read_b64_tr_b16 v[68:69], v8 offset:49152
    buffer_load_dwordx4 v2, s[40:43], s100 offen offset:1024 lds
    s_setprio 2
    s_waitcnt lgkmcnt(7)
    v_mfma_f32_16x16x32_bf16 v[48:51], v[184:187], v[88:91], v[48:51]
    ds_read_b64_tr_b16 v[70:71], v8 offset:50176
    ds_read_b64_tr_b16 v[72:73], v9 offset:49152
    v_and_b32 v29, 0xffff0000, v30
    v_mfma_f32_16x16x32_bf16 v[52:55], v[188:191], v[88:91], v[52:55]
    ds_read_b64_tr_b16 v[74:75], v9 offset:50176
    s_waitcnt lgkmcnt(8)
    v_mfma_f32_16x16x32_bf16 v[56:59], v[184:187], v[92:95], v[56:59]
    ds_read_b64_tr_b16 v[76:77], v10 offset:49152
    s_add_u32 m0, s10, 114688
    s_mov_b32 s100, 1966080
    buffer_load_dwordx4 v3, s[44:47], s100 offen lds
    v_mfma_f32_16x16x32_bf16 v[60:63], v[188:191], v[92:95], v[60:63]
    ds_read_b64_tr_b16 v[78:79], v10 offset:50176
    v_lshlrev_b32 v30, 16, v31
    s_setprio 1
    s_waitcnt lgkmcnt(7)
    v_mfma_f32_16x16x32_bf16 v[32:35], v[192:195], v[64:67], v[32:35]
    ds_read_b128 v[200:203], v6 offset:32768
    ds_read_b64_tr_b16 v[80:81], v7 offset:57344
    s_waitcnt lgkmcnt(8)
    v_mfma_f32_16x16x32_bf16 v[36:39], v[196:199], v[64:67], v[36:39]
    ds_read_b64_tr_b16 v[82:83], v7 offset:58368
    s_mov_b32 s100, 1980416
    buffer_load_dwordx4 v3, s[44:47], s100 offen offset:1024 lds
    s_waitcnt lgkmcnt(7)
    v_mfma_f32_16x16x32_bf16 v[40:43], v[192:195], v[68:71], v[40:43]
    ds_read_b128 v[204:207], v6 offset:34816
    v_and_b32 v31, 0xffff0000, v31
    v_mfma_f32_16x16x32_bf16 v[44:47], v[196:199], v[68:71], v[44:47]
    ds_read_b64_tr_b16 v[84:85], v8 offset:57344
    s_setprio 0
    s_waitcnt lgkmcnt(7)
    v_mfma_f32_16x16x32_bf16 v[48:51], v[192:195], v[72:75], v[48:51]
    ds_read_b64_tr_b16 v[86:87], v8 offset:58368
    ds_read_b64_tr_b16 v[88:89], v9 offset:57344
    v_mfma_f32_16x16x32_bf16 v[52:55], v[196:199], v[72:75], v[52:55]
    ds_read_b64_tr_b16 v[90:91], v9 offset:58368
    s_waitcnt lgkmcnt(8)
    v_mfma_f32_16x16x32_bf16 v[56:59], v[192:195], v[76:79], v[56:59]
    ds_read_b64_tr_b16 v[92:93], v10 offset:57344
    v_mfma_f32_16x16x32_bf16 v[60:63], v[196:199], v[76:79], v[60:63]
    ds_read_b64_tr_b16 v[94:95], v10 offset:58368
    v_add_u32 v5, 0x10000, v5
    v_add_u32 v6, 0x10000, v6
    v_add_u32 v7, 0x10000, v7
    v_add_u32 v8, 0x10000, v8
    v_add_u32 v9, 0x10000, v9
    v_add_u32 v10, 0x10000, v10
    s_waitcnt vmcnt(4)
    s_barrier
    s_setprio 3
    s_waitcnt lgkmcnt(7)
    v_mfma_f32_16x16x32_bf16 v[32:35], v[200:203], v[80:83], v[32:35]
    ds_read_b128 v[208:211], v5 offset:0
    ds_read_b64_tr_b16 v[64:65], v7 offset:16384
    s_add_u32 m0, s10, 131072
    s_mov_b32 s100, 1152
    buffer_load_dwordx4 v1, s[40:43], s100 offen lds
    s_waitcnt lgkmcnt(8)
    v_mfma_f32_16x16x32_bf16 v[36:39], v[204:207], v[80:83], v[36:39]
    ds_read_b64_tr_b16 v[66:67], v7 offset:17408
    s_waitcnt lgkmcnt(7)
    v_mfma_f32_16x16x32_bf16 v[40:43], v[200:203], v[84:87], v[40:43]
    ds_read_b128 v[212:215], v5 offset:2048
    v_mfma_f32_16x16x32_bf16 v[44:47], v[204:207], v[84:87], v[44:47]
    ds_read_b64_tr_b16 v[68:69], v8 offset:16384
    buffer_load_dwordx4 v2, s[40:43], s100 offen offset:1024 lds
    s_setprio 2
    s_waitcnt lgkmcnt(7)
    v_mfma_f32_16x16x32_bf16 v[48:51], v[200:203], v[88:91], v[48:51]
    ds_read_b64_tr_b16 v[70:71], v8 offset:17408
    ds_read_b64_tr_b16 v[72:73], v9 offset:16384
    v_mfma_f32_16x16x32_bf16 v[52:55], v[204:207], v[88:91], v[52:55]
    ds_read_b64_tr_b16 v[74:75], v9 offset:17408
    s_waitcnt lgkmcnt(8)
    v_mfma_f32_16x16x32_bf16 v[56:59], v[200:203], v[92:95], v[56:59]
    ds_read_b64_tr_b16 v[76:77], v10 offset:16384
    s_add_u32 m0, s10, 147456
    s_mov_b32 s100, 2211840
    buffer_load_dwordx4 v3, s[44:47], s100 offen lds
    v_mfma_f32_16x16x32_bf16 v[60:63], v[204:207], v[92:95], v[60:63]
    ds_read_b64_tr_b16 v[78:79], v10 offset:17408
    s_setprio 1
    s_waitcnt lgkmcnt(7)
    v_mfma_f32_16x16x32_bf16 v[32:35], v[208:211], v[64:67], v[32:35]
    ds_read_b128 v[216:219], v6 offset:0
    ds_read_b64_tr_b16 v[80:81], v7 offset:24576
    s_waitcnt lgkmcnt(8)
    v_mfma_f32_16x16x32_bf16 v[36:39], v[212:215], v[64:67], v[36:39]
    ds_read_b64_tr_b16 v[82:83], v7 offset:25600
    s_mov_b32 s100, 2226176
    buffer_load_dwordx4 v3, s[44:47], s100 offen offset:1024 lds
    s_waitcnt lgkmcnt(7)
    v_mfma_f32_16x16x32_bf16 v[40:43], v[208:211], v[68:71], v[40:43]
    ds_read_b128 v[220:223], v6 offset:2048
    v_mfma_f32_16x16x32_bf16 v[44:47], v[212:215], v[68:71], v[44:47]
    ds_read_b64_tr_b16 v[84:85], v8 offset:24576
    s_setprio 0
    s_waitcnt lgkmcnt(7)
    v_mfma_f32_16x16x32_bf16 v[48:51], v[208:211], v[72:75], v[48:51]
    ds_read_b64_tr_b16 v[86:87], v8 offset:25600
    ds_read_b64_tr_b16 v[88:89], v9 offset:24576
    v_mfma_f32_16x16x32_bf16 v[52:55], v[212:215], v[72:75], v[52:55]
    ds_read_b64_tr_b16 v[90:91], v9 offset:25600
    s_waitcnt lgkmcnt(8)
    v_mfma_f32_16x16x32_bf16 v[56:59], v[208:211], v[76:79], v[56:59]
    ds_read_b64_tr_b16 v[92:93], v10 offset:24576
    v_mfma_f32_16x16x32_bf16 v[60:63], v[212:215], v[76:79], v[60:63]
    ds_read_b64_tr_b16 v[94:95], v10 offset:25600
    s_waitcnt vmcnt(4)
    s_barrier
    s_setprio 3
    s_waitcnt lgkmcnt(7)
    v_mfma_f32_16x16x32_bf16 v[32:35], v[216:219], v[80:83], v[32:35]
    ds_read_b128 v[224:227], v5 offset:32768
    ds_read_b64_tr_b16 v[64:65], v7 offset:49152
    s_add_u32 m0, s10, 0
    s_mov_b32 s100, 0
    buffer_load_dwordx4 v4, s[48:51], s100 offen lds
    s_waitcnt lgkmcnt(8)
    v_mfma_f32_16x16x32_bf16 v[36:39], v[220:223], v[80:83], v[36:39]
    ds_read_b64_tr_b16 v[66:67], v7 offset:50176
    s_waitcnt lgkmcnt(7)
    v_mfma_f32_16x16x32_bf16 v[40:43], v[216:219], v[84:87], v[40:43]
    ds_read_b128 v[228:231], v5 offset:34816
    v_mfma_f32_16x16x32_bf16 v[44:47], v[220:223], v[84:87], v[44:47]
    ds_read_b64_tr_b16 v[68:69], v8 offset:49152
    s_mov_b32 s100, 12800
    buffer_load_dwordx4 v4, s[48:51], s100 offen offset:1024 lds
    s_setprio 2
    s_waitcnt lgkmcnt(7)
    v_mfma_f32_16x16x32_bf16 v[48:51], v[216:219], v[88:91], v[48:51]
    ds_read_b64_tr_b16 v[70:71], v8 offset:50176
    ds_read_b64_tr_b16 v[72:73], v9 offset:49152
    v_mfma_f32_16x16x32_bf16 v[52:55], v[220:223], v[88:91], v[52:55]
    ds_read_b64_tr_b16 v[74:75], v9 offset:50176
    s_waitcnt lgkmcnt(8)
    v_mfma_f32_16x16x32_bf16 v[56:59], v[216:219], v[92:95], v[56:59]
    ds_read_b64_tr_b16 v[76:77], v10 offset:49152
    s_add_u32 m0, s10, 16384
    s_mov_b32 s100, 221184
    buffer_load_dwordx4 v4, s[48:51], s100 offen lds
    v_mfma_f32_16x16x32_bf16 v[60:63], v[220:223], v[92:95], v[60:63]
    ds_read_b64_tr_b16 v[78:79], v10 offset:50176
    s_setprio 1
    s_waitcnt lgkmcnt(7)
    v_mfma_f32_16x16x32_bf16 v[32:35], v[224:227], v[64:67], v[32:35]
    ds_read_b128 v[232:235], v6 offset:32768
    ds_read_b64_tr_b16 v[80:81], v7 offset:57344
    s_waitcnt lgkmcnt(8)
    v_mfma_f32_16x16x32_bf16 v[36:39], v[228:231], v[64:67], v[36:39]
    ds_read_b64_tr_b16 v[82:83], v7 offset:58368
    s_mov_b32 s100, 233984
    buffer_load_dwordx4 v4, s[48:51], s100 offen offset:1024 lds
    s_waitcnt lgkmcnt(7)
    v_mfma_f32_16x16x32_bf16 v[40:43], v[224:227], v[68:71], v[40:43]
    ds_read_b128 v[236:239], v6 offset:34816
    v_mfma_f32_16x16x32_bf16 v[44:47], v[228:231], v[68:71], v[44:47]
    ds_read_b64_tr_b16 v[84:85], v8 offset:57344
    s_setprio 0
    s_waitcnt lgkmcnt(7)
    v_mfma_f32_16x16x32_bf16 v[48:51], v[224:227], v[72:75], v[48:51]
    ds_read_b64_tr_b16 v[86:87], v8 offset:58368
    ds_read_b64_tr_b16 v[88:89], v9 offset:57344
    v_mfma_f32_16x16x32_bf16 v[52:55], v[228:231], v[72:75], v[52:55]
    ds_read_b64_tr_b16 v[90:91], v9 offset:58368
    s_waitcnt lgkmcnt(8)
    v_mfma_f32_16x16x32_bf16 v[56:59], v[224:227], v[76:79], v[56:59]
    ds_read_b64_tr_b16 v[92:93], v10 offset:57344
    v_mfma_f32_16x16x32_bf16 v[60:63], v[228:231], v[76:79], v[60:63]
    ds_read_b64_tr_b16 v[94:95], v10 offset:58368
    v_add_u32 v5, 0x10000, v5
    v_add_u32 v6, 0x10000, v6
    v_add_u32 v7, 0x10000, v7
    v_add_u32 v8, 0x10000, v8
    v_add_u32 v9, 0x10000, v9
    v_add_u32 v10, 0x10000, v10
    s_waitcnt vmcnt(4)
    s_barrier
    s_setprio 3
    s_waitcnt lgkmcnt(7)
    v_mfma_f32_16x16x32_bf16 v[32:35], v[232:235], v[80:83], v[32:35]
    ds_read_b128 v[240:243], v5 offset:0
    ds_read_b64_tr_b16 v[64:65], v7 offset:16384
    s_add_u32 m0, s10, 32768
    s_mov_b32 s100, 442368
    buffer_load_dwordx4 v4, s[48:51], s100 offen lds
    s_waitcnt lgkmcnt(8)
    v_mfma_f32_16x16x32_bf16 v[36:39], v[236:239], v[80:83], v[36:39]
    ds_read_b64_tr_b16 v[66:67], v7 offset:17408
    s_waitcnt lgkmcnt(7)
    v_mfma_f32_16x16x32_bf16 v[40:43], v[232:235], v[84:87], v[40:43]
    ds_read_b128 v[244:247], v5 offset:2048
    v_mfma_f32_16x16x32_bf16 v[44:47], v[236:239], v[84:87], v[44:47]
    ds_read_b64_tr_b16 v[68:69], v8 offset:16384
    s_mov_b32 s100, 455168
    buffer_load_dwordx4 v4, s[48:51], s100 offen offset:1024 lds
    s_setprio 2
    s_waitcnt lgkmcnt(7)
    v_mfma_f32_16x16x32_bf16 v[48:51], v[232:235], v[88:91], v[48:51]
    ds_read_b64_tr_b16 v[70:71], v8 offset:17408
    ds_read_b64_tr_b16 v[72:73], v9 offset:16384
    v_mfma_f32_16x16x32_bf16 v[52:55], v[236:239], v[88:91], v[52:55]
    ds_read_b64_tr_b16 v[74:75], v9 offset:17408
    s_waitcnt lgkmcnt(8)
    v_mfma_f32_16x16x32_bf16 v[56:59], v[232:235], v[92:95], v[56:59]
    ds_read_b64_tr_b16 v[76:77], v10 offset:16384
    s_add_u32 m0, s10, 49152
    s_mov_b32 s100, 663552
    buffer_load_dwordx4 v4, s[48:51], s100 offen lds
    v_mfma_f32_16x16x32_bf16 v[60:63], v[236:239], v[92:95], v[60:63]
    ds_read_b64_tr_b16 v[78:79], v10 offset:17408
    s_setprio 1
    s_waitcnt lgkmcnt(7)
    v_mfma_f32_16x16x32_bf16 v[32:35], v[240:243], v[64:67], v[32:35]
    ds_read_b128 v[248:251], v6 offset:0
    ds_read_b64_tr_b16 v[80:81], v7 offset:24576
    s_waitcnt lgkmcnt(8)
    v_mfma_f32_16x16x32_bf16 v[36:39], v[244:247], v[64:67], v[36:39]
    ds_read_b64_tr_b16 v[82:83], v7 offset:25600
    s_mov_b32 s100, 676352
    buffer_load_dwordx4 v4, s[48:51], s100 offen offset:1024 lds
    s_waitcnt lgkmcnt(7)
    v_mfma_f32_16x16x32_bf16 v[40:43], v[240:243], v[68:71], v[40:43]
    ds_read_b128 v[252:255], v6 offset:2048
    v_mfma_f32_16x16x32_bf16 v[44:47], v[244:247], v[68:71], v[44:47]
    ds_read_b64_tr_b16 v[84:85], v8 offset:24576
    s_setprio 0
    s_waitcnt lgkmcnt(7)
    v_mfma_f32_16x16x32_bf16 v[48:51], v[240:243], v[72:75], v[48:51]
    ds_read_b64_tr_b16 v[86:87], v8 offset:25600
    ds_read_b64_tr_b16 v[88:89], v9 offset:24576
    v_mfma_f32_16x16x32_bf16 v[52:55], v[244:247], v[72:75], v[52:55]
    ds_read_b64_tr_b16 v[90:91], v9 offset:25600
    s_waitcnt lgkmcnt(8)
    v_mfma_f32_16x16x32_bf16 v[56:59], v[240:243], v[76:79], v[56:59]
    ds_read_b64_tr_b16 v[92:93], v10 offset:24576
    v_mfma_f32_16x16x32_bf16 v[60:63], v[244:247], v[76:79], v[60:63]
    ds_read_b64_tr_b16 v[94:95], v10 offset:25600
    v_xor_b32 v7, 0, v15
    v_xor_b32 v8, 32, v15
    v_xor_b32 v9, 64, v15
    v_xor_b32 v10, 96, v15
    s_waitcnt vmcnt(4)
    s_barrier
    s_setprio 3
    s_waitcnt lgkmcnt(7)
    v_mfma_f32_16x16x32_bf16 v[32:35], v[248:251], v[80:83], v[32:35]
    ds_read_b64_tr_b16 v[64:65], v7 offset:0
    s_add_u32 m0, s10, 65536
    s_mov_b32 s100, 884736
    buffer_load_dwordx4 v4, s[48:51], s100 offen lds
    s_waitcnt lgkmcnt(7)
    v_mfma_f32_16x16x32_bf16 v[36:39], v[252:255], v[80:83], v[36:39]
    ds_read_b64_tr_b16 v[66:67], v7 offset:1024
    s_mov_b32 s100, 897536
    buffer_load_dwordx4 v4, s[48:51], s100 offen offset:1024 lds
    s_waitcnt lgkmcnt(6)
    v_mfma_f32_16x16x32_bf16 v[40:43], v[248:251], v[84:87], v[40:43]
    ds_read_b64_tr_b16 v[68:69], v8 offset:0
    s_add_u32 m0, s10, 81920
    s_mov_b32 s100, 1105920
    buffer_load_dwordx4 v4, s[48:51], s100 offen lds
    v_mfma_f32_16x16x32_bf16 v[44:47], v[252:255], v[84:87], v[44:47]
    ds_read_b64_tr_b16 v[70:71], v8 offset:1024
    s_mov_b32 s100, 1118720
    buffer_load_dwordx4 v4, s[48:51], s100 offen offset:1024 lds
    s_waitcnt lgkmcnt(6)
    v_mfma_f32_16x16x32_bf16 v[48:51], v[248:251], v[88:91], v[48:51]
    ds_read_b64_tr_b16 v[72:73], v9 offset:0
    v_and_b32 v1, 15, v0
    v_lshlrev_b32 v1, 2, v1
    s_lshl_b32 s12, s3, 20
    buffer_load_dword v2, v1, s[76:79], s12 offen sc1
    v_mfma_f32_16x16x32_bf16 v[52:55], v[252:255], v[88:91], v[52:55]
    ds_read_b64_tr_b16 v[74:75], v9 offset:1024
    s_waitcnt lgkmcnt(6)
    v_mfma_f32_16x16x32_bf16 v[56:59], v[248:251], v[92:95], v[56:59]
    ds_read_b64_tr_b16 v[76:77], v10 offset:0
    v_mfma_f32_16x16x32_bf16 v[60:63], v[252:255], v[92:95], v[60:63]
    ds_read_b64_tr_b16 v[78:79], v10 offset:1024
    v_cvt_pk_bf16_f32 v32, v32, v33
    v_cvt_pk_bf16_f32 v33, v34, v35
    v_cvt_pk_bf16_f32 v34, v36, v37
    v_cvt_pk_bf16_f32 v35, v38, v39
    v_cvt_pk_bf16_f32 v36, v40, v41
    v_cvt_pk_bf16_f32 v37, v42, v43
    v_cvt_pk_bf16_f32 v38, v44, v45
    v_cvt_pk_bf16_f32 v39, v46, v47
    buffer_store_dwordx4 v[32:35], v11, s[52:55], s88 offen sc1
    v_cvt_pk_bf16_f32 v40, v48, v49
    v_cvt_pk_bf16_f32 v41, v50, v51
    v_cvt_pk_bf16_f32 v42, v52, v53
    v_cvt_pk_bf16_f32 v43, v54, v55
    v_cvt_pk_bf16_f32 v44, v56, v57
    v_cvt_pk_bf16_f32 v45, v58, v59
    v_cvt_pk_bf16_f32 v46, v60, v61
    v_cvt_pk_bf16_f32 v47, v62, v63
L_p2:
    s_cmp_eq_u32 s7, 14
    s_cbranch_scc1 L_p2g
    s_setprio 2
    s_waitcnt lgkmcnt(6)
    v_mfma_f32_16x16x32_bf16 v[48:51], v[64:67], v[100:103], v[16:19]
    ds_read_b64_tr_b16 v[80:81], v7 offset:8192
    v_mfma_f32_16x16x32_bf16 v[16:19], v[64:67], v[96:99], v[16:19]
    ds_read_b64_tr_b16 v[82:83], v7 offset:9216
    s_waitcnt lgkmcnt(6)
    v_mfma_f32_16x16x32_bf16 v[52:55], v[68:71], v[100:103], v[20:23]
    ds_read_b64_tr_b16 v[84:85], v8 offset:8192
    v_mfma_f32_16x16x32_bf16 v[20:23], v[68:71], v[96:99], v[20:23]
    ds_read_b64_tr_b16 v[86:87], v8 offset:9216
    s_waitcnt lgkmcnt(6)
    v_mfma_f32_16x16x32_bf16 v[56:59], v[72:75], v[100:103], v[24:27]
    ds_read_b64_tr_b16 v[88:89], v9 offset:8192
    v_mfma_f32_16x16x32_bf16 v[24:27], v[72:75], v[96:99], v[24:27]
    ds_read_b64_tr_b16 v[90:91], v9 offset:9216
    buffer_store_dwordx4 v[36:39], v12, s[52:55], s88 offen sc1
    s_waitcnt lgkmcnt(6)
    v_mfma_f32_16x16x32_bf16 v[60:63], v[76:79], v[100:103], v[28:31]
    ds_read_b64_tr_b16 v[92:93], v10 offset:8192
    v_mfma_f32_16x16x32_bf16 v[28:31], v[76:79], v[96:99], v[28:31]
    ds_read_b64_tr_b16 v[94:95], v10 offset:9216
    s_setprio 1
    s_waitcnt lgkmcnt(6)
    v_mfma_f32_16x16x32_bf16 v[48:51], v[80:83], v[108:111], v[48:51]
    ds_read_b64_tr_b16 v[64:65], v7 offset:16384
    v_mfma_f32_16x16x32_bf16 v[16:19], v[80:83], v[104:107], v[16:19]
    ds_read_b64_tr_b16 v[66:67], v7 offset:17408
    v_lshlrev_b32 v96, 4, v0
    s_waitcnt lgkmcnt(6)
    v_mfma_f32_16x16x32_bf16 v[52:55], v[84:87], v[108:111], v[52:55]
    ds_read_b64_tr_b16 v[68:69], v8 offset:16384
    v_mfma_f32_16x16x32_bf16 v[20:23], v[84:87], v[104:107], v[20:23]
    ds_read_b64_tr_b16 v[70:71], v8 offset:17408
    buffer_store_dwordx4 v[40:43], v13, s[52:55], s88 offen sc1
    s_waitcnt lgkmcnt(6)
    v_mfma_f32_16x16x32_bf16 v[56:59], v[88:91], v[108:111], v[56:59]
    ds_read_b64_tr_b16 v[72:73], v9 offset:16384
    v_mfma_f32_16x16x32_bf16 v[24:27], v[88:91], v[104:107], v[24:27]
    ds_read_b64_tr_b16 v[74:75], v9 offset:17408
    s_mul_i32 s15, s80, 20
    v_and_b32 v3, 1, v0
    s_waitcnt lgkmcnt(6)
    v_mfma_f32_16x16x32_bf16 v[60:63], v[92:95], v[108:111], v[60:63]
    ds_read_b64_tr_b16 v[76:77], v10 offset:16384
    v_mfma_f32_16x16x32_bf16 v[28:31], v[92:95], v[104:107], v[28:31]
    ds_read_b64_tr_b16 v[78:79], v10 offset:17408
    v_mad_u32_u24 v3, v3, 19, s15
    s_setprio 0
    s_waitcnt lgkmcnt(6)
    v_mfma_f32_16x16x32_bf16 v[48:51], v[64:67], v[116:119], v[48:51]
    ds_read_b64_tr_b16 v[80:81], v7 offset:24576
    v_mfma_f32_16x16x32_bf16 v[16:19], v[64:67], v[112:115], v[16:19]
    ds_read_b64_tr_b16 v[82:83], v7 offset:25600
    buffer_store_dwordx4 v[44:47], v14, s[52:55], s88 offen sc1
    s_waitcnt lgkmcnt(6)
    v_mfma_f32_16x16x32_bf16 v[52:55], v[68:71], v[116:119], v[52:55]
    ds_read_b64_tr_b16 v[84:85], v8 offset:24576
    v_mfma_f32_16x16x32_bf16 v[20:23], v[68:71], v[112:115], v[20:23]
    ds_read_b64_tr_b16 v[86:87], v8 offset:25600
    v_lshrrev_b32 v3, 7, v3
    s_waitcnt lgkmcnt(6)
    v_mfma_f32_16x16x32_bf16 v[56:59], v[72:75], v[116:119], v[56:59]
    ds_read_b64_tr_b16 v[88:89], v9 offset:24576
    v_mfma_f32_16x16x32_bf16 v[24:27], v[72:75], v[112:115], v[24:27]
    ds_read_b64_tr_b16 v[90:91], v9 offset:25600
    v_lshrrev_b32 v5, 2, v0
    s_waitcnt lgkmcnt(6)
    v_mfma_f32_16x16x32_bf16 v[60:63], v[76:79], v[116:119], v[60:63]
    ds_read_b64_tr_b16 v[92:93], v10 offset:24576
    v_mfma_f32_16x16x32_bf16 v[28:31], v[76:79], v[112:115], v[28:31]
    ds_read_b64_tr_b16 v[94:95], v10 offset:25600
    v_mad_u32_u24 v3, v5, 5, v3
    s_waitcnt vmcnt(9)
    s_barrier
    s_setprio 3
    s_waitcnt lgkmcnt(6)
    v_mfma_f32_16x16x32_bf16 v[48:51], v[80:83], v[124:127], v[48:51]
    ds_read_b64_tr_b16 v[64:65], v7 offset:32768
    v_mfma_f32_16x16x32_bf16 v[16:19], v[80:83], v[120:123], v[16:19]
    ds_read_b64_tr_b16 v[66:67], v7 offset:33792
    v_bfe_u32 v6, v0, 1, 1
    s_waitcnt lgkmcnt(6)
    v_mfma_f32_16x16x32_bf16 v[52:55], v[84:87], v[124:127], v[52:55]
    ds_read_b64_tr_b16 v[68:69], v8 offset:32768
    v_mfma_f32_16x16x32_bf16 v[20:23], v[84:87], v[120:123], v[20:23]
    ds_read_b64_tr_b16 v[70:71], v8 offset:33792
    v_lshl_add_u32 v6, v6, 3, s3
    s_waitcnt lgkmcnt(6)
    v_mfma_f32_16x16x32_bf16 v[56:59], v[88:91], v[124:127], v[56:59]
    ds_read_b64_tr_b16 v[72:73], v9 offset:32768
    v_mfma_f32_16x16x32_bf16 v[24:27], v[88:91], v[120:123], v[24:27]
    ds_read_b64_tr_b16 v[74:75], v9 offset:33792
    s_lshr_b32 s15, s81, 2
    s_mov_b64 exec, 15
    v_mov_b32 v6, s15
    s_mov_b64 exec, -1
    s_waitcnt lgkmcnt(6)
    v_mfma_f32_16x16x32_bf16 v[60:63], v[92:95], v[124:127], v[60:63]
    ds_read_b64_tr_b16 v[76:77], v10 offset:32768
    v_mfma_f32_16x16x32_bf16 v[28:31], v[92:95], v[120:123], v[28:31]
    ds_read_b64_tr_b16 v[78:79], v10 offset:33792
    v_lshl_add_u32 v3, v3, 4, v6
    s_setprio 2
    s_waitcnt lgkmcnt(6)
    v_mfma_f32_16x16x32_bf16 v[48:51], v[64:67], v[132:135], v[48:51]
    ds_read_b64_tr_b16 v[80:81], v7 offset:40960
    v_mfma_f32_16x16x32_bf16 v[16:19], v[64:67], v[128:131], v[16:19]
    ds_read_b64_tr_b16 v[82:83], v7 offset:41984
    v_lshlrev_b32 v100, 7, v3
    s_waitcnt lgkmcnt(6)
    v_mfma_f32_16x16x32_bf16 v[52:55], v[68:71], v[132:135], v[52:55]
    ds_read_b64_tr_b16 v[84:85], v8 offset:40960
    v_mfma_f32_16x16x32_bf16 v[20:23], v[68:71], v[128:131], v[20:23]
    ds_read_b64_tr_b16 v[86:87], v8 offset:41984
    v_bfe_u32 v5, v0, 4, 1
    s_waitcnt lgkmcnt(6)
    v_mfma_f32_16x16x32_bf16 v[56:59], v[72:75], v[132:135], v[56:59]
    ds_read_b64_tr_b16 v[88:89], v9 offset:40960
    v_mfma_f32_16x16x32_bf16 v[24:27], v[72:75], v[128:131], v[24:27]
    ds_read_b64_tr_b16 v[90:91], v9 offset:41984
    v_lshlrev_b32 v5, 3, v5
    s_waitcnt lgkmcnt(6)
    v_mfma_f32_16x16x32_bf16 v[60:63], v[76:79], v[132:135], v[60:63]
    ds_read_b64_tr_b16 v[92:93], v10 offset:40960
    v_mfma_f32_16x16x32_bf16 v[28:31], v[76:79], v[128:131], v[28:31]
    ds_read_b64_tr_b16 v[94:95], v10 offset:41984
    v_and_b32 v6, 15, v0
    s_setprio 1
    s_waitcnt lgkmcnt(6)
    v_mfma_f32_16x16x32_bf16 v[48:51], v[80:83], v[140:143], v[48:51]
    ds_read_b64_tr_b16 v[64:65], v7 offset:49152
    s_add_u32 m0, s10, 98304
    s_mov_b32 s100, 1327104
    buffer_load_dwordx4 v4, s[48:51], s100 offen lds
    v_mfma_f32_16x16x32_bf16 v[16:19], v[80:83], v[136:139], v[16:19]
    ds_read_b64_tr_b16 v[66:67], v7 offset:50176
    v_lshl_add_u32 v97, v6, 4, v5
    s_waitcnt lgkmcnt(6)
    v_mfma_f32_16x16x32_bf16 v[52:55], v[84:87], v[140:143], v[52:55]
    ds_read_b64_tr_b16 v[68:69], v8 offset:49152
    v_mfma_f32_16x16x32_bf16 v[20:23], v[84:87], v[136:139], v[20:23]
    ds_read_b64_tr_b16 v[70:71], v8 offset:50176
    s_waitcnt lgkmcnt(6)
    v_mfma_f32_16x16x32_bf16 v[56:59], v[88:91], v[140:143], v[56:59]
    ds_read_b64_tr_b16 v[72:73], v9 offset:49152
    v_mfma_f32_16x16x32_bf16 v[24:27], v[88:91], v[136:139], v[24:27]
    ds_read_b64_tr_b16 v[74:75], v9 offset:50176
    s_waitcnt lgkmcnt(6)
    v_mfma_f32_16x16x32_bf16 v[60:63], v[92:95], v[140:143], v[60:63]
    ds_read_b64_tr_b16 v[76:77], v10 offset:49152
    v_mfma_f32_16x16x32_bf16 v[28:31], v[92:95], v[136:139], v[28:31]
    ds_read_b64_tr_b16 v[78:79], v10 offset:50176
    s_setprio 0
    s_waitcnt lgkmcnt(6)
    v_mfma_f32_16x16x32_bf16 v[48:51], v[64:67], v[148:151], v[48:51]
    ds_read_b64_tr_b16 v[80:81], v7 offset:57344
    s_mov_b32 s100, 1339904
    buffer_load_dwordx4 v4, s[48:51], s100 offen offset:1024 lds
    v_mfma_f32_16x16x32_bf16 v[16:19], v[64:67], v[144:147], v[16:19]
    ds_read_b64_tr_b16 v[82:83], v7 offset:58368
    s_waitcnt lgkmcnt(6)
    v_mfma_f32_16x16x32_bf16 v[52:55], v[68:71], v[148:151], v[52:55]
    ds_read_b64_tr_b16 v[84:85], v8 offset:57344
    v_mfma_f32_16x16x32_bf16 v[20:23], v[68:71], v[144:147], v[20:23]
    ds_read_b64_tr_b16 v[86:87], v8 offset:58368
    s_waitcnt lgkmcnt(6)
    v_mfma_f32_16x16x32_bf16 v[56:59], v[72:75], v[148:151], v[56:59]
    ds_read_b64_tr_b16 v[88:89], v9 offset:57344
    v_mfma_f32_16x16x32_bf16 v[24:27], v[72:75], v[144:147], v[24:27]
    ds_read_b64_tr_b16 v[90:91], v9 offset:58368
    s_waitcnt lgkmcnt(6)
    v_mfma_f32_16x16x32_bf16 v[60:63], v[76:79], v[148:151], v[60:63]
    ds_read_b64_tr_b16 v[92:93], v10 offset:57344
    v_mfma_f32_16x16x32_bf16 v[28:31], v[76:79], v[144:147], v[28:31]
    ds_read_b64_tr_b16 v[94:95], v10 offset:58368
    v_add_u32 v7, 0x10000, v7
    v_add_u32 v8, 0x10000, v8
    v_add_u32 v9, 0x10000, v9
    v_add_u32 v10, 0x10000, v10
    s_waitcnt vmcnt(2)
    s_barrier
    s_cmp_eq_u32 s3, 0
    s_cbranch_scc1 L_fl_9
L_flr_10:
    s_setprio 3
    s_waitcnt lgkmcnt(6)
    v_mfma_f32_16x16x32_bf16 v[48:51], v[80:83], v[156:159], v[48:51]
    ds_read_b64_tr_b16 v[64:65], v7 offset:0
    s_add_u32 m0, s10, 114688
    s_mov_b32 s100, 1548288
    buffer_load_dwordx4 v4, s[48:51], s100 offen lds
    v_mfma_f32_16x16x32_bf16 v[16:19], v[80:83], v[152:155], v[16:19]
    ds_read_b64_tr_b16 v[66:67], v7 offset:1024
    s_waitcnt lgkmcnt(6)
    v_mfma_f32_16x16x32_bf16 v[52:55], v[84:87], v[156:159], v[52:55]
    ds_read_b64_tr_b16 v[68:69], v8 offset:0
    v_mfma_f32_16x16x32_bf16 v[20:23], v[84:87], v[152:155], v[20:23]
    ds_read_b64_tr_b16 v[70:71], v8 offset:1024
    s_waitcnt lgkmcnt(6)
    v_mfma_f32_16x16x32_bf16 v[56:59], v[88:91], v[156:159], v[56:59]
    ds_read_b64_tr_b16 v[72:73], v9 offset:0
    v_mfma_f32_16x16x32_bf16 v[24:27], v[88:91], v[152:155], v[24:27]
    ds_read_b64_tr_b16 v[74:75], v9 offset:1024
    s_waitcnt lgkmcnt(6)
    v_mfma_f32_16x16x32_bf16 v[60:63], v[92:95], v[156:159], v[60:63]
    ds_read_b64_tr_b16 v[76:77], v10 offset:0
    v_mfma_f32_16x16x32_bf16 v[28:31], v[92:95], v[152:155], v[28:31]
    ds_read_b64_tr_b16 v[78:79], v10 offset:1024
    s_setprio 2
    s_waitcnt lgkmcnt(6)
    v_mfma_f32_16x16x32_bf16 v[48:51], v[64:67], v[164:167], v[48:51]
    ds_read_b64_tr_b16 v[80:81], v7 offset:8192
    s_mov_b32 s100, 1561088
    buffer_load_dwordx4 v4, s[48:51], s100 offen offset:1024 lds
    v_mfma_f32_16x16x32_bf16 v[16:19], v[64:67], v[160:163], v[16:19]
    ds_read_b64_tr_b16 v[82:83], v7 offset:9216
    v_lshrrev_b32 v3, 5, v0
    s_waitcnt lgkmcnt(6)
    v_mfma_f32_16x16x32_bf16 v[52:55], v[68:71], v[164:167], v[52:55]
    ds_read_b64_tr_b16 v[84:85], v8 offset:8192
    v_mfma_f32_16x16x32_bf16 v[20:23], v[68:71], v[160:163], v[20:23]
    ds_read_b64_tr_b16 v[86:87], v8 offset:9216
    v_bfe_u32 v5, v0, 3, 2
    s_waitcnt lgkmcnt(6)
    v_mfma_f32_16x16x32_bf16 v[56:59], v[72:75], v[164:167], v[56:59]
    ds_read_b64_tr_b16 v[88:89], v9 offset:8192
    v_mfma_f32_16x16x32_bf16 v[24:27], v[72:75], v[160:163], v[24:27]
    ds_read_b64_tr_b16 v[90:91], v9 offset:9216
    v_and_b32 v6, 3, v0
    s_waitcnt lgkmcnt(6)
    v_mfma_f32_16x16x32_bf16 v[60:63], v[76:79], v[164:167], v[60:63]
    ds_read_b64_tr_b16 v[92:93], v10 offset:8192
    v_mfma_f32_16x16x32_bf16 v[28:31], v[76:79], v[160:163], v[28:31]
    ds_read_b64_tr_b16 v[94:95], v10 offset:9216
    v_lshl_add_u32 v5, v5, 2, v6
    s_setprio 1
    s_waitcnt lgkmcnt(6)
    v_mfma_f32_16x16x32_bf16 v[48:51], v[80:83], v[172:175], v[48:51]
    ds_read_b64_tr_b16 v[64:65], v7 offset:16384
    s_add_u32 m0, s10, 131072
    s_mov_b32 s100, 1769472
    buffer_load_dwordx4 v4, s[48:51], s100 offen lds
    v_mfma_f32_16x16x32_bf16 v[16:19], v[80:83], v[168:171], v[16:19]
    ds_read_b64_tr_b16 v[66:67], v7 offset:17408
    v_bfe_u32 v6, v0, 2, 1
    s_waitcnt lgkmcnt(6)
    v_mfma_f32_16x16x32_bf16 v[52:55], v[84:87], v[172:175], v[52:55]
    ds_read_b64_tr_b16 v[68:69], v8 offset:16384
    v_mfma_f32_16x16x32_bf16 v[20:23], v[84:87], v[168:171], v[20:23]
    ds_read_b64_tr_b16 v[70:71], v8 offset:17408
    v_lshlrev_b32 v15, 9, v3
    s_waitcnt lgkmcnt(6)
    v_mfma_f32_16x16x32_bf16 v[56:59], v[88:91], v[172:175], v[56:59]
    ds_read_b64_tr_b16 v[72:73], v9 offset:16384
    v_mfma_f32_16x16x32_bf16 v[24:27], v[88:91], v[168:171], v[24:27]
    ds_read_b64_tr_b16 v[74:75], v9 offset:17408
    v_lshl_add_u32 v15, v6, 8, v15
    s_waitcnt lgkmcnt(6)
    v_mfma_f32_16x16x32_bf16 v[60:63], v[92:95], v[172:175], v[60:63]
    ds_read_b64_tr_b16 v[76:77], v10 offset:16384
    v_mfma_f32_16x16x32_bf16 v[28:31], v[92:95], v[168:171], v[28:31]
    ds_read_b64_tr_b16 v[78:79], v10 offset:17408
    v_lshl_add_u32 v104, v5, 4, v15
    s_setprio 0
    s_waitcnt lgkmcnt(6)
    v_mfma_f32_16x16x32_bf16 v[48:51], v[64:67], v[180:183], v[48:51]
    ds_read_b64_tr_b16 v[80:81], v7 offset:24576
    s_mov_b32 s100, 1782272
    buffer_load_dwordx4 v4, s[48:51], s100 offen offset:1024 lds
    v_mfma_f32_16x16x32_bf16 v[16:19], v[64:67], v[176:179], v[16:19]
    ds_read_b64_tr_b16 v[82:83], v7 offset:25600
    v_mul_u32_u24 v15, 2560, v3
    s_waitcnt lgkmcnt(6)
    v_mfma_f32_16x16x32_bf16 v[52:55], v[68:71], v[180:183], v[52:55]
    ds_read_b64_tr_b16 v[84:85], v8 offset:24576
    v_mfma_f32_16x16x32_bf16 v[20:23], v[68:71], v[176:179], v[20:23]
    ds_read_b64_tr_b16 v[86:87], v8 offset:25600
    v_lshl_add_u32 v15, v5, 4, v15
    s_waitcnt lgkmcnt(6)
    v_mfma_f32_16x16x32_bf16 v[56:59], v[72:75], v[180:183], v[56:59]
    ds_read_b64_tr_b16 v[88:89], v9 offset:24576
    v_mfma_f32_16x16x32_bf16 v[24:27], v[72:75], v[176:179], v[24:27]
    ds_read_b64_tr_b16 v[90:91], v9 offset:25600
    v_lshl_add_u32 v105, v6, 3, v15
    s_waitcnt lgkmcnt(6)
    v_mfma_f32_16x16x32_bf16 v[60:63], v[76:79], v[180:183], v[60:63]
    ds_read_b64_tr_b16 v[92:93], v10 offset:24576
    v_mfma_f32_16x16x32_bf16 v[28:31], v[76:79], v[176:179], v[28:31]
    ds_read_b64_tr_b16 v[94:95], v10 offset:25600
    v_mul_u32_u24 v15, 192, v3
    s_waitcnt vmcnt(2)
    s_barrier
    s_setprio 3
    s_waitcnt lgkmcnt(6)
    v_mfma_f32_16x16x32_bf16 v[48:51], v[80:83], v[188:191], v[48:51]
    ds_read_b64_tr_b16 v[64:65], v7 offset:32768
    s_add_u32 m0, s10, 147456
    s_mov_b32 s100, 1990656
    buffer_load_dwordx4 v4, s[48:51], s100 offen lds
    v_mfma_f32_16x16x32_bf16 v[16:19], v[80:83], v[184:187], v[16:19]
    ds_read_b64_tr_b16 v[66:67], v7 offset:33792
    v_sub_u32 v132, v96, v15
    s_waitcnt lgkmcnt(6)
    v_mfma_f32_16x16x32_bf16 v[52:55], v[84:87], v[188:191], v[52:55]
    ds_read_b64_tr_b16 v[68:69], v8 offset:32768
    v_mfma_f32_16x16x32_bf16 v[20:23], v[84:87], v[184:187], v[20:23]
    ds_read_b64_tr_b16 v[70:71], v8 offset:33792
    v_mov_b32 v133, 0xdddddddd
    s_waitcnt lgkmcnt(6)
    v_mfma_f32_16x16x32_bf16 v[56:59], v[88:91], v[188:191], v[56:59]
    ds_read_b64_tr_b16 v[72:73], v9 offset:32768
    v_mfma_f32_16x16x32_bf16 v[24:27], v[88:91], v[184:187], v[24:27]
    ds_read_b64_tr_b16 v[74:75], v9 offset:33792
    v_mov_b64 v[110:111], 0
    s_waitcnt lgkmcnt(6)
    v_mfma_f32_16x16x32_bf16 v[60:63], v[92:95], v[188:191], v[60:63]
    ds_read_b64_tr_b16 v[76:77], v10 offset:32768
    v_mfma_f32_16x16x32_bf16 v[28:31], v[92:95], v[184:187], v[28:31]
    ds_read_b64_tr_b16 v[78:79], v10 offset:33792
    v_mov_b64 v[120:121], 0
    s_setprio 2
    s_waitcnt lgkmcnt(6)
    v_mfma_f32_16x16x32_bf16 v[48:51], v[64:67], v[196:199], v[48:51]
    ds_read_b64_tr_b16 v[80:81], v7 offset:40960
    s_mov_b32 s100, 2003456
    buffer_load_dwordx4 v4, s[48:51], s100 offen offset:1024 lds
    v_mfma_f32_16x16x32_bf16 v[16:19], v[64:67], v[192:195], v[16:19]
    ds_read_b64_tr_b16 v[82:83], v7 offset:41984
    s_mov_b32 exec_lo, 0x11000000
    s_mov_b32 exec_hi, 0x11000000
    v_mov_b32 v120, 0x3f803f80
    v_mov_b32 v121, 0x3f803f80
    s_mov_b64 exec, -1
    s_waitcnt lgkmcnt(6)
    v_mfma_f32_16x16x32_bf16 v[52:55], v[68:71], v[196:199], v[52:55]
    ds_read_b64_tr_b16 v[84:85], v8 offset:40960
    s_mov_b64 exec, 0xfff
    buffer_load_dword v101, v100, s[52:55], 0 offen sc1
    s_mov_b64 exec, -1
    v_mfma_f32_16x16x32_bf16 v[20:23], v[68:71], v[192:195], v[20:23]
    ds_read_b64_tr_b16 v[86:87], v8 offset:41984
    v_mov_b64 v[122:123], v[120:121]
    s_waitcnt lgkmcnt(6)
    v_mfma_f32_16x16x32_bf16 v[56:59], v[72:75], v[196:199], v[56:59]
    ds_read_b64_tr_b16 v[88:89], v9 offset:40960
    v_mfma_f32_16x16x32_bf16 v[24:27], v[72:75], v[192:195], v[24:27]
    ds_read_b64_tr_b16 v[90:91], v9 offset:41984
    v_mov_b64 v[124:125], v[120:121]
    s_waitcnt lgkmcnt(6)
    v_mfma_f32_16x16x32_bf16 v[60:63], v[76:79], v[196:199], v[60:63]
    ds_read_b64_tr_b16 v[92:93], v10 offset:40960
    v_mfma_f32_16x16x32_bf16 v[28:31], v[76:79], v[192:195], v[28:31]
    ds_read_b64_tr_b16 v[94:95], v10 offset:41984
    v_mov_b64 v[126:127], v[120:121]
    s_setprio 1
    s_waitcnt lgkmcnt(6)
    v_mfma_f32_16x16x32_bf16 v[48:51], v[80:83], v[204:207], v[48:51]
    ds_read_b64_tr_b16 v[64:65], v7 offset:49152
    v_mfma_f32_16x16x32_bf16 v[16:19], v[80:83], v[200:203], v[16:19]
    ds_read_b64_tr_b16 v[66:67], v7 offset:50176
    v_mov_b64 v[128:129], v[120:121]
    s_waitcnt lgkmcnt(6)
    v_mfma_f32_16x16x32_bf16 v[52:55], v[84:87], v[204:207], v[52:55]
    ds_read_b64_tr_b16 v[68:69], v8 offset:49152
    v_mfma_f32_16x16x32_bf16 v[20:23], v[84:87], v[200:203], v[20:23]
    ds_read_b64_tr_b16 v[70:71], v8 offset:50176
    v_mov_b64 v[130:131], v[120:121]
    s_waitcnt lgkmcnt(6)
    v_mfma_f32_16x16x32_bf16 v[56:59], v[88:91], v[204:207], v[56:59]
    ds_read_b64_tr_b16 v[72:73], v9 offset:49152
    v_mfma_f32_16x16x32_bf16 v[24:27], v[88:91], v[200:203], v[24:27]
    ds_read_b64_tr_b16 v[74:75], v9 offset:50176
    v_mfma_f32_32x32x8_bf16 v[136:151], v[110:111], v[110:111], 0
    s_waitcnt lgkmcnt(6)
    v_mfma_f32_16x16x32_bf16 v[60:63], v[92:95], v[204:207], v[60:63]
    ds_read_b64_tr_b16 v[76:77], v10 offset:49152
    v_mfma_f32_16x16x32_bf16 v[28:31], v[92:95], v[200:203], v[28:31]
    ds_read_b64_tr_b16 v[78:79], v10 offset:50176
    v_lshlrev_b32 v98, 2, v0
    s_setprio 0
    s_waitcnt lgkmcnt(6)
    v_mfma_f32_16x16x32_bf16 v[48:51], v[64:67], v[212:215], v[48:51]
    ds_read_b64_tr_b16 v[80:81], v7 offset:57344
    v_mfma_f32_16x16x32_bf16 v[16:19], v[64:67], v[208:211], v[16:19]
    ds_read_b64_tr_b16 v[82:83], v7 offset:58368
    v_and_b32 v99, 60, v98
    s_waitcnt lgkmcnt(6)
    v_mfma_f32_16x16x32_bf16 v[52:55], v[68:71], v[212:215], v[52:55]
    ds_read_b64_tr_b16 v[84:85], v8 offset:57344
    v_mfma_f32_16x16x32_bf16 v[20:23], v[68:71], v[208:211], v[20:23]
    ds_read_b64_tr_b16 v[86:87], v8 offset:58368
    v_and_b32 v98, 124, v98
    s_waitcnt lgkmcnt(6)
    v_mfma_f32_16x16x32_bf16 v[56:59], v[72:75], v[212:215], v[56:59]
    ds_read_b64_tr_b16 v[88:89], v9 offset:57344
    v_mfma_f32_16x16x32_bf16 v[24:27], v[72:75], v[208:211], v[24:27]
    ds_read_b64_tr_b16 v[90:91], v9 offset:58368
    s_waitcnt lgkmcnt(6)
    v_mfma_f32_16x16x32_bf16 v[60:63], v[76:79], v[212:215], v[60:63]
    ds_read_b64_tr_b16 v[92:93], v10 offset:57344
    v_mfma_f32_16x16x32_bf16 v[28:31], v[76:79], v[208:211], v[28:31]
    ds_read_b64_tr_b16 v[94:95], v10 offset:58368
    v_add_u32 v7, 0x10000, v7
    v_add_u32 v8, 0x10000, v8
    v_add_u32 v9, 0x10000, v9
    v_add_u32 v10, 0x10000, v10
    s_waitcnt vmcnt(1)
    s_barrier
    s_setprio 0
    s_waitcnt lgkmcnt(6)
    v_mfma_f32_16x16x32_bf16 v[48:51], v[80:83], v[220:223], v[48:51]
    ds_read_b64_tr_b16 v[64:65], v7 offset:0
    s_waitcnt vmcnt(0)
    v_cmp_gt_u32 vcc, 1, v101
    s_and_b32 s11, vcc_lo, 0xfff
    s_cbranch_scc1 L_plp_12
L_pok_11:
    v_mfma_f32_16x16x32_bf16 v[16:19], v[80:83], v[216:219], v[16:19]
    ds_read_b64_tr_b16 v[66:67], v7 offset:1024
    s_waitcnt lgkmcnt(6)
    v_mfma_f32_16x16x32_bf16 v[52:55], v[84:87], v[220:223], v[52:55]
    ds_read_b64_tr_b16 v[68:69], v8 offset:0
    buffer_load_dwordx4 v[112:115], v96, s[52:55], s90 offen sc1
    v_mfma_f32_16x16x32_bf16 v[20:23], v[84:87], v[216:219], v[20:23]
    ds_read_b64_tr_b16 v[70:71], v8 offset:1024
    s_waitcnt lgkmcnt(6)
    v_mfma_f32_16x16x32_bf16 v[56:59], v[88:91], v[220:223], v[56:59]
    ds_read_b64_tr_b16 v[72:73], v9 offset:0
    buffer_load_dwordx2 v[106:107], v97, s[52:55], s90 offen offset:1024 sc1
    v_mfma_f32_16x16x32_bf16 v[24:27], v[88:91], v[216:219], v[24:27]
    ds_read_b64_tr_b16 v[74:75], v9 offset:1024
    s_waitcnt lgkmcnt(6)
    v_mfma_f32_16x16x32_bf16 v[60:63], v[92:95], v[220:223], v[60:63]
    ds_read_b64_tr_b16 v[76:77], v10 offset:0
    s_add_u32 m0, s1, 0
    s_add_u32 s100, s101, 0
    buffer_load_dwordx4 v96, s[52:55], s100 offen sc1 lds
    v_mfma_f32_16x16x32_bf16 v[28:31], v[92:95], v[216:219], v[28:31]
    ds_read_b64_tr_b16 v[78:79], v10 offset:1024
    s_waitcnt lgkmcnt(6)
    v_mfma_f32_16x16x32_bf16 v[48:51], v[64:67], v[228:231], v[48:51]
    ds_read_b64_tr_b16 v[80:81], v7 offset:8192
    buffer_load_dwordx4 v96, s[52:55], s100 offen offset:1024 sc1 lds
    v_mfma_f32_16x16x32_bf16 v[16:19], v[64:67], v[224:227], v[16:19]
    ds_read_b64_tr_b16 v[82:83], v7 offset:9216
    s_waitcnt lgkmcnt(6)
    v_mfma_f32_16x16x32_bf16 v[52:55], v[68:71], v[228:231], v[52:55]
    ds_read_b64_tr_b16 v[84:85], v8 offset:8192
    buffer_load_dwordx4 v96, s[52:55], s100 offen offset:2048 sc1 lds
    v_mfma_f32_16x16x32_bf16 v[20:23], v[68:71], v[224:227], v[20:23]
    ds_read_b64_tr_b16 v[86:87], v8 offset:9216
    s_waitcnt lgkmcnt(6)
    v_mfma_f32_16x16x32_bf16 v[56:59], v[72:75], v[228:231], v[56:59]
    ds_read_b64_tr_b16 v[88:89], v9 offset:8192
    buffer_load_dwordx4 v96, s[52:55], s100 offen offset:3072 sc1 lds
    v_mfma_f32_16x16x32_bf16 v[24:27], v[72:75], v[224:227], v[24:27]
    ds_read_b64_tr_b16 v[90:91], v9 offset:9216
    s_waitcnt lgkmcnt(6)
    v_mfma_f32_16x16x32_bf16 v[60:63], v[76:79], v[228:231], v[60:63]
    ds_read_b64_tr_b16 v[92:93], v10 offset:8192
    s_add_u32 m0, s1, 4096
    s_add_u32 s100, s101, 4096
    buffer_load_dwordx4 v96, s[52:55], s100 offen sc1 lds
    v_mfma_f32_16x16x32_bf16 v[28:31], v[76:79], v[224:227], v[28:31]
    ds_read_b64_tr_b16 v[94:95], v10 offset:9216
    s_waitcnt lgkmcnt(6)
    v_mfma_f32_16x16x32_bf16 v[48:51], v[80:83], v[236:239], v[48:51]
    ds_read_b64_tr_b16 v[64:65], v7 offset:16384
    v_mfma_f32_16x16x32_bf16 v[16:19], v[80:83], v[232:235], v[16:19]
    ds_read_b64_tr_b16 v[66:67], v7 offset:17408
    s_waitcnt lgkmcnt(6)
    v_mfma_f32_16x16x32_bf16 v[52:55], v[84:87], v[236:239], v[52:55]
    ds_read_b64_tr_b16 v[68:69], v8 offset:16384
    v_mfma_f32_16x16x32_bf16 v[20:23], v[84:87], v[232:235], v[20:23]
    ds_read_b64_tr_b16 v[70:71], v8 offset:17408
    s_waitcnt lgkmcnt(6)
    v_mfma_f32_16x16x32_bf16 v[56:59], v[88:91], v[236:239], v[56:59]
    ds_read_b64_tr_b16 v[72:73], v9 offset:16384
    v_mfma_f32_16x16x32_bf16 v[24:27], v[88:91], v[232:235], v[24:27]
    ds_read_b64_tr_b16 v[74:75], v9 offset:17408
    s_waitcnt lgkmcnt(6)
    v_mfma_f32_16x16x32_bf16 v[60:63], v[92:95], v[236:239], v[60:63]
    ds_read_b64_tr_b16 v[76:77], v10 offset:16384
    v_mfma_f32_16x16x32_bf16 v[28:31], v[92:95], v[232:235], v[28:31]
    ds_read_b64_tr_b16 v[78:79], v10 offset:17408
    s_waitcnt lgkmcnt(6)
    v_mfma_f32_16x16x32_bf16 v[48:51], v[64:67], v[244:247], v[48:51]
    ds_read_b64_tr_b16 v[80:81], v7 offset:24576
    v_mfma_f32_16x16x32_bf16 v[16:19], v[64:67], v[240:243], v[16:19]
    ds_read_b64_tr_b16 v[82:83], v7 offset:25600
    s_waitcnt lgkmcnt(6)
    v_mfma_f32_16x16x32_bf16 v[52:55], v[68:71], v[244:247], v[52:55]
    ds_read_b64_tr_b16 v[84:85], v8 offset:24576
    v_mfma_f32_16x16x32_bf16 v[20:23], v[68:71], v[240:243], v[20:23]
    ds_read_b64_tr_b16 v[86:87], v8 offset:25600
    s_waitcnt lgkmcnt(6)
    v_mfma_f32_16x16x32_bf16 v[56:59], v[72:75], v[244:247], v[56:59]
    ds_read_b64_tr_b16 v[88:89], v9 offset:24576
    v_mfma_f32_16x16x32_bf16 v[24:27], v[72:75], v[240:243], v[24:27]
    ds_read_b64_tr_b16 v[90:91], v9 offset:25600
    s_waitcnt lgkmcnt(6)
    v_mfma_f32_16x16x32_bf16 v[60:63], v[76:79], v[244:247], v[60:63]
    ds_read_b64_tr_b16 v[92:93], v10 offset:24576
    v_mfma_f32_16x16x32_bf16 v[28:31], v[76:79], v[240:243], v[28:31]
    ds_read_b64_tr_b16 v[94:95], v10 offset:25600
    s_waitcnt lgkmcnt(6)
    v_mfma_f32_16x16x32_bf16 v[48:51], v[80:83], v[252:255], v[48:51]
    v_mfma_f32_16x16x32_bf16 v[16:19], v[80:83], v[248:251], v[16:19]
    s_waitcnt lgkmcnt(4)
    v_mfma_f32_16x16x32_bf16 v[52:55], v[84:87], v[252:255], v[52:55]
    v_mfma_f32_16x16x32_bf16 v[20:23], v[84:87], v[248:251], v[20:23]
    s_waitcnt lgkmcnt(2)
    v_mfma_f32_16x16x32_bf16 v[56:59], v[88:91], v[252:255], v[56:59]
    v_mfma_f32_16x16x32_bf16 v[24:27], v[88:91], v[248:251], v[24:27]
    s_waitcnt lgkmcnt(0)
    v_mfma_f32_16x16x32_bf16 v[60:63], v[92:95], v[252:255], v[60:63]
    v_mfma_f32_16x16x32_bf16 v[28:31], v[92:95], v[248:251], v[28:31]
    s_setprio 0
    v_mul_f32 v48, v48, abs(v48)
    v_mul_f32 v49, v49, abs(v49)
    v_mul_f32 v50, v50, abs(v50)
    v_mul_f32 v51, v51, abs(v51)
    v_mul_f32 v52, v52, abs(v52)
    v_mul_f32 v53, v53, abs(v53)
    v_mul_f32 v54, v54, abs(v54)
    v_mul_f32 v55, v55, abs(v55)
    v_mul_f32 v16, v16, abs(v16)
    v_mul_f32 v17, v17, abs(v17)
    v_mul_f32 v18, v18, abs(v18)
    v_mul_f32 v19, v19, abs(v19)
    v_mul_f32 v20, v20, abs(v20)
    v_mul_f32 v21, v21, abs(v21)
    v_mul_f32 v22, v22, abs(v22)
    v_mul_f32 v23, v23, abs(v23)
    v_cvt_pk_bf16_f32 v64, v16, v17
    v_cvt_pk_bf16_f32 v65, v18, v19
    v_cvt_pk_bf16_f32 v66, v20, v21
    v_cvt_pk_bf16_f32 v67, v22, v23
    v_cvt_pk_bf16_f32 v68, v48, v49
    v_cvt_pk_bf16_f32 v69, v50, v51
    v_cvt_pk_bf16_f32 v70, v52, v53
    v_cvt_pk_bf16_f32 v71, v54, v55
    v_pk_max_i16 v64, v64, 0
    v_pk_max_i16 v65, v65, 0
    v_pk_max_i16 v66, v66, 0
    v_pk_max_i16 v67, v67, 0
    v_pk_max_i16 v68, v68, 0
    v_pk_max_i16 v69, v69, 0
    v_pk_max_i16 v70, v70, 0
    v_pk_max_i16 v71, v71, 0
    v_mul_f32 v56, v56, abs(v56)
    v_mul_f32 v57, v57, abs(v57)
    v_mul_f32 v58, v58, abs(v58)
    v_mul_f32 v59, v59, abs(v59)
    v_mul_f32 v60, v60, abs(v60)
    v_mul_f32 v61, v61, abs(v61)
    v_mul_f32 v62, v62, abs(v62)
    v_mul_f32 v63, v63, abs(v63)
    v_mul_f32 v24, v24, abs(v24)
    v_mul_f32 v25, v25, abs(v25)
    v_mul_f32 v26, v26, abs(v26)
    v_mul_f32 v27, v27, abs(v27)
    v_mul_f32 v28, v28, abs(v28)
    v_mul_f32 v29, v29, abs(v29)
    v_mul_f32 v30, v30, abs(v30)
    v_mul_f32 v31, v31, abs(v31)
    v_cvt_pk_bf16_f32 v72, v24, v25
    v_cvt_pk_bf16_f32 v73, v26, v27
    v_cvt_pk_bf16_f32 v74, v28, v29
    v_cvt_pk_bf16_f32 v75, v30, v31
    v_cvt_pk_bf16_f32 v76, v56, v57
    v_cvt_pk_bf16_f32 v77, v58, v59
    v_cvt_pk_bf16_f32 v78, v60, v61
    v_cvt_pk_bf16_f32 v79, v62, v63
    v_pk_max_i16 v72, v72, 0
    v_pk_max_i16 v73, v73, 0
    v_pk_max_i16 v74, v74, 0
    v_pk_max_i16 v75, v75, 0
    v_pk_max_i16 v76, v76, 0
    v_pk_max_i16 v77, v77, 0
    v_pk_max_i16 v78, v78, 0
    v_pk_max_i16 v79, v79, 0
L_att:
    buffer_store_dwordx4 v[64:67], v96, s[52:55], s95 offen offset:0 sc1
    buffer_store_dwordx4 v[68:71], v96, s[52:55], s95 offen offset:1024 sc1
    s_lshl_b32 s12, s3, 12
    v_lshl_add_u32 v100, v0, 7, s12
    v_mov_b32 v1, 2
    s_waitcnt vmcnt(2)
    v_mov_b32 v108, v106
    v_mov_b32 v109, v107
    s_mov_b32 exec_hi, 0
    v_mov_b32 v108, 0
    v_mov_b32 v109, 0
    s_not_b64 exec, exec
    v_mov_b32 v106, 0
    v_mov_b32 v107, 0
    s_mov_b64 exec, -1
    s_barrier
    ds_read_b128 v[116:119], v104 offset:0
    ds_read_b64 v[110:111], v105 offset:1024
    s_setprio 2
    s_waitcnt lgkmcnt(0)
    v_mfma_f32_32x32x8_bf16 v[152:167], v[110:111], v[106:107], 0
    buffer_store_dwordx4 v[72:75], v96, s[52:55], s95 offen offset:2048 sc1
    s_mov_b64 exec, s[86:87]
    ds_read_b128 v[120:123], v132 offset:1280
    ds_read_b128 v[124:127], v132 offset:1920
    s_mov_b64 exec, -1
    v_mfma_f32_32x32x16_bf16 v[152:167], v[116:119], v[112:115], v[152:167]
    ds_read_b128 v[116:119], v104 offset:2560
    s_mul_i32 s14, s83, 5120
    s_add_u32 s14, s14, 15269888
    s_mul_i32 s15, s3, 286720
    s_add_u32 s92, s15, s14
    s_nop 5
    s_setprio 0
    v_exp_f32 v152, v152
    v_exp_f32 v153, v153
    v_exp_f32 v154, v154
    v_exp_f32 v155, v155
    v_exp_f32 v156, v156
    v_exp_f32 v157, v157
    v_exp_f32 v158, v158
    v_exp_f32 v159, v159
    s_setprio 1
    v_exp_f32 v160, v160
    v_exp_f32 v161, v161
    v_exp_f32 v162, v162
    v_exp_f32 v163, v163
    v_exp_f32 v164, v164
    v_exp_f32 v165, v165
    v_exp_f32 v166, v166
    v_exp_f32 v167, v167
    s_setprio 2
    v_mfma_f32_32x32x8_bf16 v[168:183], v[110:111], v[108:109], 0
    ds_read_b64 v[110:111], v105 offset:6144
    s_mul_i32 s15, s8, 204800
    s_add_u32 s15, s15, s14
    s_add_u32 s94, s15, 2457600
    s_waitcnt lgkmcnt(3)
    v_smfmac_f32_32x32x32_bf16 v[136:151], v[120:123], v[152:159], v133
    s_mov_b64 exec, s[86:87]
    ds_read_b128 v[120:123], v132 offset:3840
    ds_read_b128 v[128:131], v132 offset:4480
    s_mov_b64 exec, -1
    s_waitcnt lgkmcnt(3)
    v_mfma_f32_32x32x16_bf16 v[168:183], v[116:119], v[112:115], v[168:183]
    ds_read_b128 v[116:119], v104 offset:5120
    s_mul_i32 s14, s9, 81920
    s_add_u32 s15, s15, s14
    s_add_u32 s88, s15, 2293760
    s_lshl1_add_u32 s84, s82, s9
    s_nop 4
    v_smfmac_f32_32x32x32_bf16 v[136:151], v[124:127], v[160:167], v133
    s_setprio 0
    v_exp_f32 v168, v168
    v_exp_f32 v169, v169
    v_exp_f32 v170, v170
    v_exp_f32 v171, v171
    v_exp_f32 v172, v172
    v_exp_f32 v173, v173
    v_exp_f32 v174, v174
    v_exp_f32 v175, v175
    s_setprio 1
    v_exp_f32 v176, v176
    v_exp_f32 v177, v177
    v_exp_f32 v178, v178
    v_exp_f32 v179, v179
    v_exp_f32 v180, v180
    v_exp_f32 v181, v181
    v_exp_f32 v182, v182
    v_exp_f32 v183, v183
    s_setprio 2
    s_waitcnt lgkmcnt(3)
    v_mfma_f32_32x32x8_bf16 v[152:167], v[110:111], v[106:107], 0
    buffer_store_dwordx4 v[76:79], v96, s[52:55], s95 offen offset:3072 sc1
    s_waitcnt lgkmcnt(2)
    v_smfmac_f32_32x32x32_bf16 v[136:151], v[120:123], v[168:175], v133
    s_mov_b64 exec, s[86:87]
    ds_read_b128 v[120:123], v132 offset:6400
    ds_read_b128 v[124:127], v132 offset:7040
    s_mov_b64 exec, -1
    s_waitcnt lgkmcnt(2)
    v_mfma_f32_32x32x16_bf16 v[152:167], v[116:119], v[112:115], v[152:167]
    ds_read_b128 v[116:119], v104 offset:7680
    s_mul_i32 s14, s3, 14336
    s_add_u32 s14, s14, 7929856
    s_mul_i32 s15, s84, 114688
    s_add_u32 s91, s15, s14
    s_nop 4
    v_smfmac_f32_32x32x32_bf16 v[136:151], v[128:131], v[176:183], v133
    s_setprio 0
    v_exp_f32 v152, v152
    v_exp_f32 v153, v153
    v_exp_f32 v154, v154
    v_exp_f32 v155, v155
    v_exp_f32 v156, v156
    v_exp_f32 v157, v157
    v_exp_f32 v158, v158
    v_exp_f32 v159, v159
    s_setprio 1
    v_exp_f32 v160, v160
    v_exp_f32 v161, v161
    v_exp_f32 v162, v162
    v_exp_f32 v163, v163
    v_exp_f32 v164, v164
    v_exp_f32 v165, v165
    v_exp_f32 v166, v166
    v_exp_f32 v167, v167
    s_setprio 2
    v_mfma_f32_32x32x8_bf16 v[168:183], v[110:111], v[108:109], 0
    ds_read_b64 v[110:111], v105 offset:11264
    s_xor_b32 s15, s84, 1
    s_mul_i32 s15, s15, 114688
    s_add_u32 s93, s15, s14
    s_waitcnt lgkmcnt(3)
    v_smfmac_f32_32x32x32_bf16 v[136:151], v[120:123], v[152:159], v133
    s_mov_b64 exec, s[86:87]
    ds_read_b128 v[120:123], v132 offset:8960
    ds_read_b128 v[128:131], v132 offset:9600
    s_mov_b64 exec, -1
    s_waitcnt lgkmcnt(3)
    v_mfma_f32_32x32x16_bf16 v[168:183], v[116:119], v[112:115], v[168:183]
    ds_read_b128 v[116:119], v104 offset:10240
    s_nop 8
    v_smfmac_f32_32x32x32_bf16 v[136:151], v[124:127], v[160:167], v133
    s_setprio 0
    v_exp_f32 v168, v168
    v_exp_f32 v169, v169
    v_exp_f32 v170, v170
    v_exp_f32 v171, v171
    v_exp_f32 v172, v172
    v_exp_f32 v173, v173
    v_exp_f32 v174, v174
    v_exp_f32 v175, v175
    s_setprio 1
    v_exp_f32 v176, v176
    v_exp_f32 v177, v177
    v_exp_f32 v178, v178
    v_exp_f32 v179, v179
    v_exp_f32 v180, v180
    v_exp_f32 v181, v181
    v_exp_f32 v182, v182
    v_exp_f32 v183, v183
    s_setprio 2
    s_waitcnt lgkmcnt(3)
    v_mfma_f32_32x32x8_bf16 v[152:167], v[110:111], v[106:107], 0
    s_add_u32 m0, s1, 40960
    s_add_u32 s100, s101, 5120
    buffer_load_dwordx4 v96, s[52:55], s100 offen sc1 lds
    s_waitcnt lgkmcnt(2)
    v_smfmac_f32_32x32x32_bf16 v[136:151], v[120:123], v[168:175], v133
    s_mov_b64 exec, s[86:87]
    ds_read_b128 v[120:123], v132 offset:11520
    ds_read_b128 v[124:127], v132 offset:12160
    s_mov_b64 exec, -1
    s_waitcnt lgkmcnt(2)
    v_mfma_f32_32x32x16_bf16 v[152:167], v[116:119], v[112:115], v[152:167]
    ds_read_b128 v[116:119], v104 offset:12800
    buffer_load_dwordx4 v96, s[52:55], s100 offen offset:1024 sc1 lds
    s_nop 7
    v_smfmac_f32_32x32x32_bf16 v[136:151], v[128:131], v[176:183], v133
    s_setprio 0
    v_exp_f32 v152, v152
    v_exp_f32 v153, v153
    v_exp_f32 v154, v154
    v_exp_f32 v155, v155
    v_exp_f32 v156, v156
    v_exp_f32 v157, v157
    v_exp_f32 v158, v158
    v_exp_f32 v159, v159
    s_setprio 1
    v_exp_f32 v160, v160
    v_exp_f32 v161, v161
    v_exp_f32 v162, v162
    v_exp_f32 v163, v163
    v_exp_f32 v164, v164
    v_exp_f32 v165, v165
    v_exp_f32 v166, v166
    v_exp_f32 v167, v167
    s_setprio 2
    v_mfma_f32_32x32x8_bf16 v[168:183], v[110:111], v[108:109], 0
    ds_read_b64 v[110:111], v105 offset:16384
    buffer_load_dwordx4 v96, s[52:55], s100 offen offset:2048 sc1 lds
    s_waitcnt lgkmcnt(3)
    v_smfmac_f32_32x32x32_bf16 v[136:151], v[120:123], v[152:159], v133
    s_mov_b64 exec, s[86:87]
    ds_read_b128 v[120:123], v132 offset:14080
    ds_read_b128 v[128:131], v132 offset:14720
    s_mov_b64 exec, -1
    s_waitcnt lgkmcnt(3)
    v_mfma_f32_32x32x16_bf16 v[168:183], v[116:119], v[112:115], v[168:183]
    ds_read_b128 v[116:119], v104 offset:15360
    buffer_load_dwordx4 v96, s[52:55], s100 offen offset:3072 sc1 lds
    s_nop 7
    v_smfmac_f32_32x32x32_bf16 v[136:151], v[124:127], v[160:167], v133
    s_setprio 0
    v_exp_f32 v168, v168
    v_exp_f32 v169, v169
    v_exp_f32 v170, v170
    v_exp_f32 v171, v171
    v_exp_f32 v172, v172
    v_exp_f32 v173, v173
    v_exp_f32 v174, v174
    v_exp_f32 v175, v175
    s_setprio 1
    v_exp_f32 v176, v176
    v_exp_f32 v177, v177
    v_exp_f32 v178, v178
    v_exp_f32 v179, v179
    v_exp_f32 v180, v180
    v_exp_f32 v181, v181
    v_exp_f32 v182, v182
    v_exp_f32 v183, v183
    s_setprio 2
    s_waitcnt lgkmcnt(3)
    v_mfma_f32_32x32x8_bf16 v[152:167], v[110:111], v[106:107], 0
    s_add_u32 m0, s1, 45056
    s_add_u32 s100, s101, 9216
    buffer_load_dwordx4 v96, s[52:55], s100 offen sc1 lds
    s_waitcnt lgkmcnt(2)
    v_smfmac_f32_32x32x32_bf16 v[136:151], v[120:123], v[168:175], v133
    s_mov_b64 exec, s[86:87]
    ds_read_b128 v[120:123], v132 offset:16640
    ds_read_b128 v[124:127], v132 offset:17280
    s_mov_b64 exec, -1
    s_waitcnt lgkmcnt(2)
    v_mfma_f32_32x32x16_bf16 v[152:167], v[116:119], v[112:115], v[152:167]
    ds_read_b128 v[116:119], v104 offset:17920
    s_nop 8
    v_smfmac_f32_32x32x32_bf16 v[136:151], v[128:131], v[176:183], v133
    s_setprio 0
    v_exp_f32 v152, v152
    v_exp_f32 v153, v153
    v_exp_f32 v154, v154
    v_exp_f32 v155, v155
    v_exp_f32 v156, v156
    v_exp_f32 v157, v157
    v_exp_f32 v158, v158
    v_exp_f32 v159, v159
    s_setprio 1
    v_exp_f32 v160, v160
    v_exp_f32 v161, v161
    v_exp_f32 v162, v162
    v_exp_f32 v163, v163
    v_exp_f32 v164, v164
    v_exp_f32 v165, v165
    v_exp_f32 v166, v166
    v_exp_f32 v167, v167
    s_setprio 2
    v_mfma_f32_32x32x8_bf16 v[168:183], v[110:111], v[108:109], 0
    ds_read_b64 v[110:111], v105 offset:21504
    s_waitcnt lgkmcnt(3)
    v_smfmac_f32_32x32x32_bf16 v[136:151], v[120:123], v[152:159], v133
    s_mov_b64 exec, s[86:87]
    ds_read_b128 v[120:123], v132 offset:19200
    ds_read_b128 v[128:131], v132 offset:19840
    s_mov_b64 exec, -1
    s_waitcnt lgkmcnt(3)
    v_mfma_f32_32x32x16_bf16 v[168:183], v[116:119], v[112:115], v[168:183]
    ds_read_b128 v[116:119], v104 offset:20480
    s_nop 8
    v_smfmac_f32_32x32x32_bf16 v[136:151], v[124:127], v[160:167], v133
    s_setprio 0
    v_exp_f32 v168, v168
    v_exp_f32 v169, v169
    v_exp_f32 v170, v170
    v_exp_f32 v171, v171
    v_exp_f32 v172, v172
    v_exp_f32 v173, v173
    v_exp_f32 v174, v174
    v_exp_f32 v175, v175
    s_setprio 1
    v_exp_f32 v176, v176
    v_exp_f32 v177, v177
    v_exp_f32 v178, v178
    v_exp_f32 v179, v179
    v_exp_f32 v180, v180
    v_exp_f32 v181, v181
    v_exp_f32 v182, v182
    v_exp_f32 v183, v183
    s_setprio 2
    s_waitcnt lgkmcnt(3)
    v_mfma_f32_32x32x8_bf16 v[152:167], v[110:111], v[106:107], 0
    s_waitcnt lgkmcnt(2)
    v_smfmac_f32_32x32x32_bf16 v[136:151], v[120:123], v[168:175], v133
    s_mov_b64 exec, s[86:87]
    ds_read_b128 v[120:123], v132 offset:21760
    ds_read_b128 v[124:127], v132 offset:22400
    s_mov_b64 exec, -1
    s_waitcnt lgkmcnt(2)
    v_mfma_f32_32x32x16_bf16 v[152:167], v[116:119], v[112:115], v[152:167]
    ds_read_b128 v[116:119], v104 offset:23040
    s_nop 8
    v_smfmac_f32_32x32x32_bf16 v[136:151], v[128:131], v[176:183], v133
    s_waitcnt vmcnt(0)
    s_cmp_eq_u32 s9, 0
    s_cbranch_scc1 L_na8
    s_barrier
L_na8:
    s_setprio 0
    v_exp_f32 v152, v152
    v_exp_f32 v153, v153
    v_exp_f32 v154, v154
    v_exp_f32 v155, v155
    v_exp_f32 v156, v156
    v_exp_f32 v157, v157
    v_exp_f32 v158, v158
    v_exp_f32 v159, v159
    s_setprio 1
    v_exp_f32 v160, v160
    v_exp_f32 v161, v161
    v_exp_f32 v162, v162
    v_exp_f32 v163, v163
    v_exp_f32 v164, v164
    v_exp_f32 v165, v165
    v_exp_f32 v166, v166
    v_exp_f32 v167, v167
    s_setprio 2
    v_mfma_f32_32x32x8_bf16 v[168:183], v[110:111], v[108:109], 0
    ds_read_b64 v[110:111], v105 offset:26624
    s_cmp_lg_u32 s9, 0
    s_cbranch_scc1 L_nb9
    s_barrier
L_nb9:
    s_waitcnt lgkmcnt(3)
    v_smfmac_f32_32x32x32_bf16 v[136:151], v[120:123], v[152:159], v133
    s_mov_b64 exec, s[86:87]
    ds_read_b128 v[120:123], v132 offset:24320
    ds_read_b128 v[128:131], v132 offset:24960
    s_mov_b64 exec, -1
    s_waitcnt lgkmcnt(3)
    v_mfma_f32_32x32x16_bf16 v[168:183], v[116:119], v[112:115], v[168:183]
    ds_read_b128 v[116:119], v104 offset:25600
    s_lshl4_add_u32 s13, s7, s6
    s_lshl_b32 s14, s3, 19
    s_add_u32 s13, s13, s14
    s_lshl_b32 s13, s13, 7
    s_mov_b64 exec, 1
    buffer_store_dword v1, off, s[52:55], s13 sc1
    s_mov_b64 exec, -1
    s_nop 1
    v_smfmac_f32_32x32x32_bf16 v[136:151], v[124:127], v[160:167], v133
    s_setprio 0
    v_exp_f32 v168, v168
    v_exp_f32 v169, v169
    v_exp_f32 v170, v170
    v_exp_f32 v171, v171
    v_exp_f32 v172, v172
    v_exp_f32 v173, v173
    v_exp_f32 v174, v174
    v_exp_f32 v175, v175
    s_setprio 1
    v_exp_f32 v176, v176
    v_exp_f32 v177, v177
    v_exp_f32 v178, v178
    v_exp_f32 v179, v179
    v_exp_f32 v180, v180
    v_exp_f32 v181, v181
    v_exp_f32 v182, v182
    v_exp_f32 v183, v183
    s_setprio 2
    s_waitcnt lgkmcnt(3)
    v_mfma_f32_32x32x8_bf16 v[152:167], v[110:111], v[106:107], 0
    s_add_u32 m0, s1, 81920
    s_add_u32 s100, s101, 81920
    buffer_load_dwordx4 v96, s[52:55], s100 offen sc1 lds
    s_waitcnt lgkmcnt(2)
    v_smfmac_f32_32x32x32_bf16 v[136:151], v[120:123], v[168:175], v133
    s_mov_b64 exec, s[86:87]
    ds_read_b128 v[120:123], v132 offset:26880
    ds_read_b128 v[124:127], v132 offset:27520
    s_mov_b64 exec, -1
    s_waitcnt lgkmcnt(2)
    v_mfma_f32_32x32x16_bf16 v[152:167], v[116:119], v[112:115], v[152:167]
    ds_read_b128 v[116:119], v104 offset:28160
    buffer_load_dwordx4 v96, s[52:55], s100 offen offset:1024 sc1 lds
    s_nop 7
    v_smfmac_f32_32x32x32_bf16 v[136:151], v[128:131], v[176:183], v133
    s_setprio 0
    v_exp_f32 v152, v152
    v_exp_f32 v153, v153
    v_exp_f32 v154, v154
    v_exp_f32 v155, v155
    v_exp_f32 v156, v156
    v_exp_f32 v157, v157
    v_exp_f32 v158, v158
    v_exp_f32 v159, v159
    s_setprio 1
    v_exp_f32 v160, v160
    v_exp_f32 v161, v161
    v_exp_f32 v162, v162
    v_exp_f32 v163, v163
    v_exp_f32 v164, v164
    v_exp_f32 v165, v165
    v_exp_f32 v166, v166
    v_exp_f32 v167, v167
    s_setprio 2
    v_mfma_f32_32x32x8_bf16 v[168:183], v[110:111], v[108:109], 0
    ds_read_b64 v[110:111], v105 offset:31744
    buffer_load_dwordx4 v96, s[52:55], s100 offen offset:2048 sc1 lds
    s_waitcnt lgkmcnt(3)
    v_smfmac_f32_32x32x32_bf16 v[136:151], v[120:123], v[152:159], v133
    s_mov_b64 exec, s[86:87]
    ds_read_b128 v[120:123], v132 offset:29440
    ds_read_b128 v[128:131], v132 offset:30080
    s_mov_b64 exec, -1
    s_waitcnt lgkmcnt(3)
    v_mfma_f32_32x32x16_bf16 v[168:183], v[116:119], v[112:115], v[168:183]
    ds_read_b128 v[116:119], v104 offset:30720
    buffer_load_dwordx4 v96, s[52:55], s100 offen offset:3072 sc1 lds
    s_nop 7
    v_smfmac_f32_32x32x32_bf16 v[136:151], v[124:127], v[160:167], v133
    s_setprio 0
    v_exp_f32 v168, v168
    v_exp_f32 v169, v169
    v_exp_f32 v170, v170
    v_exp_f32 v171, v171
    v_exp_f32 v172, v172
    v_exp_f32 v173, v173
    v_exp_f32 v174, v174
    v_exp_f32 v175, v175
    s_setprio 1
    v_exp_f32 v176, v176
    v_exp_f32 v177, v177
    v_exp_f32 v178, v178
    v_exp_f32 v179, v179
    v_exp_f32 v180, v180
    v_exp_f32 v181, v181
    v_exp_f32 v182, v182
    v_exp_f32 v183, v183
    s_setprio 2
    s_waitcnt lgkmcnt(3)
    v_mfma_f32_32x32x8_bf16 v[152:167], v[110:111], v[106:107], 0
    s_add_u32 m0, s1, 86016
    s_add_u32 s100, s101, 86016
    buffer_load_dwordx4 v96, s[52:55], s100 offen sc1 lds
    s_waitcnt lgkmcnt(2)
    v_smfmac_f32_32x32x32_bf16 v[136:151], v[120:123], v[168:175], v133
    s_mov_b64 exec, s[86:87]
    ds_read_b128 v[120:123], v132 offset:32000
    ds_read_b128 v[124:127], v132 offset:32640
    s_mov_b64 exec, -1
    s_waitcnt lgkmcnt(2)
    v_mfma_f32_32x32x16_bf16 v[152:167], v[116:119], v[112:115], v[152:167]
    ds_read_b128 v[116:119], v104 offset:33280
    s_add_u32 m0, s1, 122880
    s_add_u32 s100, s101, 87040
    buffer_load_dwordx4 v96, s[52:55], s100 offen sc1 lds
    s_nop 5
    v_smfmac_f32_32x32x32_bf16 v[136:151], v[128:131], v[176:183], v133
    s_setprio 0
    v_exp_f32 v152, v152
    v_exp_f32 v153, v153
    v_exp_f32 v154, v154
    v_exp_f32 v155, v155
    v_exp_f32 v156, v156
    v_exp_f32 v157, v157
    v_exp_f32 v158, v158
    v_exp_f32 v159, v159
    s_setprio 1
    v_exp_f32 v160, v160
    v_exp_f32 v161, v161
    v_exp_f32 v162, v162
    v_exp_f32 v163, v163
    v_exp_f32 v164, v164
    v_exp_f32 v165, v165
    v_exp_f32 v166, v166
    v_exp_f32 v167, v167
    s_setprio 2
    v_mfma_f32_32x32x8_bf16 v[168:183], v[110:111], v[108:109], 0
    ds_read_b64 v[110:111], v105 offset:36864
    buffer_load_dwordx4 v96, s[52:55], s100 offen offset:1024 sc1 lds
    s_waitcnt lgkmcnt(3)
    v_smfmac_f32_32x32x32_bf16 v[136:151], v[120:123], v[152:159], v133
    s_mov_b64 exec, s[86:87]
    ds_read_b128 v[120:123], v132 offset:34560
    ds_read_b128 v[128:131], v132 offset:35200
    s_mov_b64 exec, -1
    s_waitcnt lgkmcnt(3)
    v_mfma_f32_32x32x16_bf16 v[168:183], v[116:119], v[112:115], v[168:183]
    ds_read_b128 v[116:119], v104 offset:35840
    buffer_load_dwordx4 v96, s[52:55], s100 offen offset:2048 sc1 lds
    s_nop 7
    v_smfmac_f32_32x32x32_bf16 v[136:151], v[124:127], v[160:167], v133
    s_setprio 0
    v_exp_f32 v168, v168
    v_exp_f32 v169, v169
    v_exp_f32 v170, v170
    v_exp_f32 v171, v171
    v_exp_f32 v172, v172
    v_exp_f32 v173, v173
    v_exp_f32 v174, v174
    v_exp_f32 v175, v175
    s_setprio 1
    v_exp_f32 v176, v176
    v_exp_f32 v177, v177
    v_exp_f32 v178, v178
    v_exp_f32 v179, v179
    v_exp_f32 v180, v180
    v_exp_f32 v181, v181
    v_exp_f32 v182, v182
    v_exp_f32 v183, v183
    s_setprio 2
    s_waitcnt lgkmcnt(3)
    v_mfma_f32_32x32x8_bf16 v[152:167], v[110:111], v[106:107], 0
    buffer_load_dwordx4 v96, s[52:55], s100 offen offset:3072 sc1 lds
    s_waitcnt lgkmcnt(2)
    v_smfmac_f32_32x32x32_bf16 v[136:151], v[120:123], v[168:175], v133
    s_mov_b64 exec, s[86:87]
    ds_read_b128 v[120:123], v132 offset:37120
    ds_read_b128 v[124:127], v132 offset:37760
    s_mov_b64 exec, -1
    s_waitcnt lgkmcnt(2)
    v_mfma_f32_32x32x16_bf16 v[152:167], v[116:119], v[112:115], v[152:167]
    ds_read_b128 v[116:119], v104 offset:38400
    s_add_u32 m0, s1, 126976
    s_add_u32 s100, s101, 91136
    buffer_load_dwordx4 v96, s[52:55], s100 offen sc1 lds
    s_nop 5
    v_smfmac_f32_32x32x32_bf16 v[136:151], v[128:131], v[176:183], v133
    s_setprio 0
    v_exp_f32 v152, v152
    v_exp_f32 v153, v153
    v_exp_f32 v154, v154
    v_exp_f32 v155, v155
    v_exp_f32 v156, v156
    v_exp_f32 v157, v157
    v_exp_f32 v158, v158
    v_exp_f32 v159, v159
    s_setprio 1
    v_exp_f32 v160, v160
    v_exp_f32 v161, v161
    v_exp_f32 v162, v162
    v_exp_f32 v163, v163
    v_exp_f32 v164, v164
    v_exp_f32 v165, v165
    v_exp_f32 v166, v166
    v_exp_f32 v167, v167
    s_setprio 2
    v_mfma_f32_32x32x8_bf16 v[168:183], v[110:111], v[108:109], 0
    ds_read_b64 v[110:111], v105 offset:41984
    s_mov_b32 exec_hi, 0
    buffer_load_dword v101, v100, s[52:55], 0 offen sc1
    s_mov_b64 exec, -1
    s_waitcnt lgkmcnt(3)
    v_smfmac_f32_32x32x32_bf16 v[136:151], v[120:123], v[152:159], v133
    s_mov_b64 exec, s[86:87]
    ds_read_b128 v[120:123], v132 offset:39680
    ds_read_b128 v[128:131], v132 offset:40320
    s_mov_b64 exec, -1
    s_waitcnt lgkmcnt(3)
    v_mfma_f32_32x32x16_bf16 v[168:183], v[116:119], v[112:115], v[168:183]
    ds_read_b128 v[116:119], v104 offset:40960
    v_and_b32 v1, 48, v0
    v_lshrrev_b32 v135, 1, v1
    s_nop 6
    v_smfmac_f32_32x32x32_bf16 v[136:151], v[124:127], v[160:167], v133
    s_setprio 0
    v_exp_f32 v168, v168
    v_exp_f32 v169, v169
    v_exp_f32 v170, v170
    v_exp_f32 v171, v171
    v_exp_f32 v172, v172
    v_exp_f32 v173, v173
    v_exp_f32 v174, v174
    v_exp_f32 v175, v175
    s_setprio 1
    v_exp_f32 v176, v176
    v_exp_f32 v177, v177
    v_exp_f32 v178, v178
    v_exp_f32 v179, v179
    v_exp_f32 v180, v180
    v_exp_f32 v181, v181
    v_exp_f32 v182, v182
    v_exp_f32 v183, v183
    s_setprio 2
    s_waitcnt lgkmcnt(3)
    v_mfma_f32_32x32x8_bf16 v[152:167], v[110:111], v[106:107], 0
    s_and_b32 s12, s3, 1
    s_lshl_b32 s12, s12, 6
    s_lshr_b32 s4, s3, 1
    s_lshl2_add_u32 s4, s82, s4
    s_mul_i32 s14, s83, 160
    s_add_u32 s12, s12, s14
    s_waitcnt lgkmcnt(2)
    v_smfmac_f32_32x32x32_bf16 v[136:151], v[120:123], v[168:175], v133
    s_mov_b64 exec, s[86:87]
    ds_read_b128 v[120:123], v132 offset:42240
    ds_read_b128 v[124:127], v132 offset:42880
    s_mov_b64 exec, -1
    s_waitcnt lgkmcnt(2)
    v_mfma_f32_32x32x16_bf16 v[152:167], v[116:119], v[112:115], v[152:167]
    ds_read_b128 v[116:119], v104 offset:43520
    buffer_load_dwordx4 v[2:5], v1, s[64:67], s12 offen
    s_mul_i32 s14, s4, 20480
    s_add_u32 s98, s14, s12
    s_nop 5
    v_smfmac_f32_32x32x32_bf16 v[136:151], v[128:131], v[176:183], v133
    s_setprio 0
    v_exp_f32 v152, v152
    v_exp_f32 v153, v153
    v_exp_f32 v154, v154
    v_exp_f32 v155, v155
    v_exp_f32 v156, v156
    v_exp_f32 v157, v157
    v_exp_f32 v158, v158
    v_exp_f32 v159, v159
    s_setprio 1
    v_exp_f32 v160, v160
    v_exp_f32 v161, v161
    v_exp_f32 v162, v162
    v_exp_f32 v163, v163
    v_exp_f32 v164, v164
    v_exp_f32 v165, v165
    v_exp_f32 v166, v166
    v_exp_f32 v167, v167
    s_setprio 2
    v_mfma_f32_32x32x8_bf16 v[168:183], v[110:111], v[108:109], 0
    ds_read_b64 v[110:111], v105 offset:47104
    s_movk_i32 s12, 128
    s_mov_b32 s5, s8
    s_lshl2_add_u32 s5, s82, s5
    s_mul_i32 s14, s83, 160
    s_add_u32 s12, s12, s14
    s_waitcnt lgkmcnt(3)
    v_smfmac_f32_32x32x32_bf16 v[136:151], v[120:123], v[152:159], v133
    s_mov_b64 exec, s[86:87]
    ds_read_b128 v[120:123], v132 offset:44800
    ds_read_b128 v[128:131], v132 offset:45440
    s_mov_b64 exec, -1
    s_waitcnt lgkmcnt(3)
    v_mfma_f32_32x32x16_bf16 v[168:183], v[116:119], v[112:115], v[168:183]
    ds_read_b128 v[116:119], v104 offset:46080
    buffer_load_dwordx2 v[6:7], v135, s[64:67], s12 offen
    s_mul_i32 s14, s5, 20480
    s_add_u32 s99, s14, s12
    s_nop 5
    v_smfmac_f32_32x32x32_bf16 v[136:151], v[124:127], v[160:167], v133
    s_waitcnt vmcnt(2)
    v_cmp_gt_u32 vcc, 2, v101
    s_and_b32 s11, vcc_lo, 0xffffffff
    s_cbranch_scc1 L_plp_14
L_pok_13:
    s_cmp_eq_u32 s9, 0
    s_cbranch_scc1 L_na17
    s_barrier
L_na17:
    s_setprio 0
    v_exp_f32 v168, v168
    v_exp_f32 v169, v169
    v_exp_f32 v170, v170
    v_exp_f32 v171, v171
    v_exp_f32 v172, v172
    v_exp_f32 v173, v173
    v_exp_f32 v174, v174
    v_exp_f32 v175, v175
    s_setprio 1
    v_exp_f32 v176, v176
    v_exp_f32 v177, v177
    v_exp_f32 v178, v178
    v_exp_f32 v179, v179
    v_exp_f32 v180, v180
    v_exp_f32 v181, v181
    v_exp_f32 v182, v182
    v_exp_f32 v183, v183
    s_setprio 2
    s_waitcnt lgkmcnt(3)
    v_mfma_f32_32x32x8_bf16 v[152:167], v[110:111], v[106:107], 0
    s_cmp_lg_u32 s9, 0
    s_cbranch_scc1 L_nb18
    s_barrier
L_nb18:
    s_waitcnt lgkmcnt(2)
    v_smfmac_f32_32x32x32_bf16 v[136:151], v[120:123], v[168:175], v133
    s_mov_b64 exec, s[86:87]
    ds_read_b128 v[120:123], v132 offset:47360
    ds_read_b128 v[124:127], v132 offset:48000
    s_mov_b64 exec, -1
    s_waitcnt lgkmcnt(2)
    v_mfma_f32_32x32x16_bf16 v[152:167], v[116:119], v[112:115], v[152:167]
    ds_read_b128 v[116:119], v104 offset:48640
    s_add_u32 s13, s92, 0
    buffer_load_dwordx4 v[200:203], v96, s[52:55], s13 offen sc1
    s_nop 6
    v_smfmac_f32_32x32x32_bf16 v[136:151], v[128:131], v[176:183], v133
    s_setprio 0
    v_exp_f32 v152, v152
    v_exp_f32 v153, v153
    v_exp_f32 v154, v154
    v_exp_f32 v155, v155
    v_exp_f32 v156, v156
    v_exp_f32 v157, v157
    v_exp_f32 v158, v158
    v_exp_f32 v159, v159
    s_setprio 1
    v_exp_f32 v160, v160
    v_exp_f32 v161, v161
    v_exp_f32 v162, v162
    v_exp_f32 v163, v163
    v_exp_f32 v164, v164
    v_exp_f32 v165, v165
    v_exp_f32 v166, v166
    v_exp_f32 v167, v167
    s_setprio 2
    v_mfma_f32_32x32x8_bf16 v[168:183], v[110:111], v[108:109], 0
    ds_read_b64 v[110:111], v105 offset:52224
    s_add_u32 s13, s91, 0
    buffer_load_dwordx4 v[184:187], v96, s[52:55], s13 offen sc1
    s_waitcnt lgkmcnt(3)
    v_smfmac_f32_32x32x32_bf16 v[136:151], v[120:123], v[152:159], v133
    s_mov_b64 exec, s[86:87]
    ds_read_b128 v[120:123], v132 offset:49920
    ds_read_b128 v[128:131], v132 offset:50560
    s_mov_b64 exec, -1
    s_waitcnt lgkmcnt(3)
    v_mfma_f32_32x32x16_bf16 v[168:183], v[116:119], v[112:115], v[168:183]
    ds_read_b128 v[116:119], v104 offset:51200
    s_add_u32 s13, s91, 1024
    buffer_load_dwordx4 v[188:191], v96, s[52:55], s13 offen sc1
    s_nop 6
    v_smfmac_f32_32x32x32_bf16 v[136:151], v[124:127], v[160:167], v133
    s_setprio 0
    v_exp_f32 v168, v168
    v_exp_f32 v169, v169
    v_exp_f32 v170, v170
    v_exp_f32 v171, v171
    v_exp_f32 v172, v172
    v_exp_f32 v173, v173
    v_exp_f32 v174, v174
    v_exp_f32 v175, v175
    s_setprio 1
    v_exp_f32 v176, v176
    v_exp_f32 v177, v177
    v_exp_f32 v178, v178
    v_exp_f32 v179, v179
    v_exp_f32 v180, v180
    v_exp_f32 v181, v181
    v_exp_f32 v182, v182
    v_exp_f32 v183, v183
    s_setprio 2
    s_waitcnt lgkmcnt(3)
    v_mfma_f32_32x32x8_bf16 v[152:167], v[110:111], v[106:107], 0
    s_add_u32 s13, s93, 0
    buffer_load_dwordx4 v[192:195], v96, s[52:55], s13 offen sc1
    s_waitcnt lgkmcnt(2)
    v_smfmac_f32_32x32x32_bf16 v[136:151], v[120:123], v[168:175], v133
    s_mov_b64 exec, s[86:87]
    ds_read_b128 v[120:123], v132 offset:52480
    ds_read_b128 v[124:127], v132 offset:53120
    s_mov_b64 exec, -1
    s_waitcnt lgkmcnt(2)
    v_mfma_f32_32x32x16_bf16 v[152:167], v[116:119], v[112:115], v[152:167]
    ds_read_b128 v[116:119], v104 offset:53760
    s_add_u32 s13, s93, 1024
    buffer_load_dwordx4 v[196:199], v96, s[52:55], s13 offen sc1
    s_nop 6
    v_smfmac_f32_32x32x32_bf16 v[136:151], v[128:131], v[176:183], v133
    s_setprio 0
    v_exp_f32 v152, v152
    v_exp_f32 v153, v153
    v_exp_f32 v154, v154
    v_exp_f32 v155, v155
    v_exp_f32 v156, v156
    v_exp_f32 v157, v157
    v_exp_f32 v158, v158
    v_exp_f32 v159, v159
    s_setprio 1
    v_exp_f32 v160, v160
    v_exp_f32 v161, v161
    v_exp_f32 v162, v162
    v_exp_f32 v163, v163
    v_exp_f32 v164, v164
    v_exp_f32 v165, v165
    v_exp_f32 v166, v166
    v_exp_f32 v167, v167
    s_setprio 2
    v_mfma_f32_32x32x8_bf16 v[168:183], v[110:111], v[108:109], 0
    ds_read_b64 v[110:111], v105 offset:57344
    s_add_u32 s13, s92, 1024
    buffer_load_dwordx4 v[204:207], v96, s[52:55], s13 offen sc1
    s_waitcnt lgkmcnt(3)
    v_smfmac_f32_32x32x32_bf16 v[136:151], v[120:123], v[152:159], v133
    s_mov_b64 exec, s[86:87]
    ds_read_b128 v[120:123], v132 offset:55040
    ds_read_b128 v[128:131], v132 offset:55680
    s_mov_b64 exec, -1
    s_waitcnt lgkmcnt(3)
    v_mfma_f32_32x32x16_bf16 v[168:183], v[116:119], v[112:115], v[168:183]
    ds_read_b128 v[116:119], v104 offset:56320
    s_add_u32 s13, s92, 2048
    buffer_load_dwordx4 v[208:211], v96, s[52:55], s13 offen sc1
    s_nop 6
    v_smfmac_f32_32x32x32_bf16 v[136:151], v[124:127], v[160:167], v133
    s_setprio 0
    v_exp_f32 v168, v168
    v_exp_f32 v169, v169
    v_exp_f32 v170, v170
    v_exp_f32 v171, v171
    v_exp_f32 v172, v172
    v_exp_f32 v173, v173
    v_exp_f32 v174, v174
    v_exp_f32 v175, v175
    s_setprio 1
    v_exp_f32 v176, v176
    v_exp_f32 v177, v177
    v_exp_f32 v178, v178
    v_exp_f32 v179, v179
    v_exp_f32 v180, v180
    v_exp_f32 v181, v181
    v_exp_f32 v182, v182
    v_exp_f32 v183, v183
    s_setprio 2
    s_waitcnt lgkmcnt(3)
    v_mfma_f32_32x32x8_bf16 v[152:167], v[110:111], v[106:107], 0
    s_add_u32 s13, s92, 3072
    buffer_load_dwordx4 v[212:215], v96, s[52:55], s13 offen sc1
    s_waitcnt lgkmcnt(2)
    v_smfmac_f32_32x32x32_bf16 v[136:151], v[120:123], v[168:175], v133
    s_mov_b64 exec, s[86:87]
    ds_read_b128 v[120:123], v132 offset:57600
    ds_read_b128 v[124:127], v132 offset:58240
    s_mov_b64 exec, -1
    s_waitcnt lgkmcnt(2)
    v_mfma_f32_32x32x16_bf16 v[152:167], v[116:119], v[112:115], v[152:167]
    ds_read_b128 v[116:119], v104 offset:58880
    s_add_u32 s13, s92, 4096
    buffer_load_dwordx4 v[216:219], v96, s[52:55], s13 offen sc1
    s_nop 5
    s_waitcnt vmcnt(4)
    v_smfmac_f32_32x32x32_bf16 v[136:151], v[128:131], v[176:183], v133
    s_setprio 0
    v_exp_f32 v152, v152
    v_exp_f32 v153, v153
    v_exp_f32 v154, v154
    v_exp_f32 v155, v155
    v_exp_f32 v156, v156
    v_exp_f32 v157, v157
    v_exp_f32 v158, v158
    v_exp_f32 v159, v159
    v_exp_f32 v160, v160
    v_exp_f32 v161, v161
    s_setprio 1
    v_exp_f32 v162, v162
    v_exp_f32 v163, v163
    s_setprio 3
    v_mfma_f32_16x16x32_bf16 v[16:19], v[200:203], v[184:187], 0
    v_exp_f32 v164, v164
    v_mfma_f32_16x16x32_bf16 v[36:39], v[200:203], v[188:191], 0
    v_exp_f32 v165, v165
    v_mfma_f32_16x16x32_bf16 v[56:59], v[200:203], v[192:195], 0
    v_exp_f32 v166, v166
    v_mfma_f32_16x16x32_bf16 v[76:79], v[200:203], v[196:199], 0
    v_exp_f32 v167, v167
    s_setprio 2
    v_mfma_f32_32x32x8_bf16 v[168:183], v[110:111], v[108:109], 0
    ds_read_b64 v[110:111], v105 offset:62464
    s_add_u32 s13, s92, 40960
    buffer_load_dwordx4 v[236:239], v96, s[52:55], s13 offen sc1
    s_waitcnt lgkmcnt(3)
    v_smfmac_f32_32x32x32_bf16 v[136:151], v[120:123], v[152:159], v133
    s_mov_b64 exec, s[86:87]
    ds_read_b128 v[120:123], v132 offset:60160
    ds_read_b128 v[128:131], v132 offset:60800
    s_mov_b64 exec, -1
    s_waitcnt lgkmcnt(3)
    v_mfma_f32_32x32x16_bf16 v[168:183], v[116:119], v[112:115], v[168:183]
    ds_read_b128 v[116:119], v104 offset:61440
    s_add_u32 s13, s91, 2048
    buffer_load_dwordx4 v[220:223], v96, s[52:55], s13 offen sc1
    s_nop 5
    s_waitcnt vmcnt(5)
    v_smfmac_f32_32x32x32_bf16 v[136:151], v[124:127], v[160:167], v133
    s_setprio 0
    v_exp_f32 v168, v168
    v_exp_f32 v169, v169
    v_exp_f32 v170, v170
    v_exp_f32 v171, v171
    v_exp_f32 v172, v172
    v_exp_f32 v173, v173
    v_exp_f32 v174, v174
    v_exp_f32 v175, v175
    v_exp_f32 v176, v176
    v_exp_f32 v177, v177
    s_setprio 1
    v_exp_f32 v178, v178
    v_exp_f32 v179, v179
    v_exp_f32 v180, v180
    s_setprio 3
    v_mfma_f32_16x16x32_bf16 v[20:23], v[204:207], v[184:187], 0
    v_exp_f32 v181, v181
    v_mfma_f32_16x16x32_bf16 v[40:43], v[204:207], v[188:191], 0
    v_exp_f32 v182, v182
    v_mfma_f32_16x16x32_bf16 v[60:63], v[204:207], v[192:195], 0
    v_exp_f32 v183, v183
    s_setprio 2
    s_waitcnt lgkmcnt(3)
    v_mfma_f32_32x32x8_bf16 v[152:167], v[110:111], v[106:107], 0
    s_add_u32 s13, s91, 3072
    buffer_load_dwordx4 v[224:227], v96, s[52:55], s13 offen sc1
    s_waitcnt lgkmcnt(2)
    v_smfmac_f32_32x32x32_bf16 v[136:151], v[120:123], v[168:175], v133
    s_mov_b64 exec, s[86:87]
    ds_read_b128 v[120:123], v132 offset:62720
    ds_read_b128 v[124:127], v132 offset:63360
    s_mov_b64 exec, -1
    s_waitcnt lgkmcnt(2)
    v_mfma_f32_32x32x16_bf16 v[152:167], v[116:119], v[112:115], v[152:167]
    v_add_u32 v104, 61440, v104
    ds_read_b128 v[116:119], v104 offset:2560
    s_add_u32 s13, s93, 2048
    buffer_load_dwordx4 v[228:231], v96, s[52:55], s13 offen sc1
    s_nop 4
    s_waitcnt vmcnt(6)
    v_smfmac_f32_32x32x32_bf16 v[136:151], v[128:131], v[176:183], v133
    s_setprio 0
    v_exp_f32 v152, v152
    v_exp_f32 v153, v153
    v_exp_f32 v154, v154
    v_exp_f32 v155, v155
    v_exp_f32 v156, v156
    v_exp_f32 v157, v157
    v_exp_f32 v158, v158
    v_exp_f32 v159, v159
    v_exp_f32 v160, v160
    v_exp_f32 v161, v161
    s_setprio 1
    v_exp_f32 v162, v162
    v_exp_f32 v163, v163
    s_setprio 3
    v_mfma_f32_16x16x32_bf16 v[80:83], v[204:207], v[196:199], 0
    v_exp_f32 v164, v164
    v_mfma_f32_16x16x32_bf16 v[24:27], v[208:211], v[184:187], 0
    v_exp_f32 v165, v165
    v_mfma_f32_16x16x32_bf16 v[44:47], v[208:211], v[188:191], 0
    v_exp_f32 v166, v166
    v_mfma_f32_16x16x32_bf16 v[64:67], v[208:211], v[192:195], 0
    v_exp_f32 v167, v167
    s_setprio 2
    v_mfma_f32_32x32x8_bf16 v[168:183], v[110:111], v[108:109], 0
    v_add_u32 v105, 61440, v105
    ds_read_b64 v[110:111], v105 offset:6144
    s_add_u32 s13, s93, 3072
    buffer_load_dwordx4 v[232:235], v96, s[52:55], s13 offen sc1
    s_waitcnt lgkmcnt(3)
    v_smfmac_f32_32x32x32_bf16 v[136:151], v[120:123], v[152:159], v133
    v_add_u32 v132, 61440, v132
    s_mov_b64 exec, s[86:87]
    ds_read_b128 v[120:123], v132 offset:3840
    ds_read_b128 v[128:131], v132 offset:4480
    s_mov_b64 exec, -1
    s_waitcnt lgkmcnt(3)
    v_mfma_f32_32x32x16_bf16 v[168:183], v[116:119], v[112:115], v[168:183]
    ds_read_b128 v[116:119], v104 offset:5120
    s_add_u32 s13, s92, 41984
    buffer_load_dwordx4 v[240:243], v96, s[52:55], s13 offen sc1
    s_nop 5
    s_waitcnt vmcnt(7)
    v_smfmac_f32_32x32x32_bf16 v[136:151], v[124:127], v[160:167], v133
    s_setprio 0
    v_exp_f32 v168, v168
    v_exp_f32 v169, v169
    v_exp_f32 v170, v170
    v_exp_f32 v171, v171
    v_exp_f32 v172, v172
    v_exp_f32 v173, v173
    v_exp_f32 v174, v174
    v_exp_f32 v175, v175
    v_exp_f32 v176, v176
    v_exp_f32 v177, v177
    s_setprio 1
    v_exp_f32 v178, v178
    v_exp_f32 v179, v179
    v_exp_f32 v180, v180
    s_setprio 3
    v_mfma_f32_16x16x32_bf16 v[84:87], v[208:211], v[196:199], 0
    v_exp_f32 v181, v181
    v_mfma_f32_16x16x32_bf16 v[28:31], v[212:215], v[184:187], 0
    v_exp_f32 v182, v182
    v_mfma_f32_16x16x32_bf16 v[48:51], v[212:215], v[188:191], 0
    v_exp_f32 v183, v183
    s_setprio 2
    s_waitcnt lgkmcnt(3)
    v_mfma_f32_32x32x8_bf16 v[152:167], v[110:111], v[106:107], 0
    s_add_u32 s13, s92, 43008
    buffer_load_dwordx4 v[244:247], v96, s[52:55], s13 offen sc1
    s_waitcnt lgkmcnt(2)
    v_smfmac_f32_32x32x32_bf16 v[136:151], v[120:123], v[168:175], v133
    s_mov_b64 exec, s[86:87]
    ds_read_b128 v[120:123], v132 offset:6400
    ds_read_b128 v[124:127], v132 offset:7040
    s_mov_b64 exec, -1
    s_waitcnt lgkmcnt(2)
    v_mfma_f32_32x32x16_bf16 v[152:167], v[116:119], v[112:115], v[152:167]
    ds_read_b128 v[116:119], v104 offset:7680
    s_add_u32 s13, s92, 44032
    buffer_load_dwordx4 v[248:251], v96, s[52:55], s13 offen sc1
    s_nop 5
    s_waitcnt vmcnt(8)
    v_smfmac_f32_32x32x32_bf16 v[136:151], v[128:131], v[176:183], v133
    s_setprio 0
    v_exp_f32 v152, v152
    v_exp_f32 v153, v153
    v_exp_f32 v154, v154
    v_exp_f32 v155, v155
    v_exp_f32 v156, v156
    v_exp_f32 v157, v157
    v_exp_f32 v158, v158
    v_exp_f32 v159, v159
    v_exp_f32 v160, v160
    v_exp_f32 v161, v161
    s_setprio 1
    v_exp_f32 v162, v162
    v_exp_f32 v163, v163
    s_setprio 3
    v_mfma_f32_16x16x32_bf16 v[68:71], v[212:215], v[192:195], 0
    v_exp_f32 v164, v164
    v_mfma_f32_16x16x32_bf16 v[88:91], v[212:215], v[196:199], 0
    v_exp_f32 v165, v165
    v_mfma_f32_16x16x32_bf16 v[32:35], v[216:219], v[184:187], 0
    v_exp_f32 v166, v166
    v_mfma_f32_16x16x32_bf16 v[52:55], v[216:219], v[188:191], 0
    v_exp_f32 v167, v167
    s_setprio 2
    v_mfma_f32_32x32x8_bf16 v[168:183], v[110:111], v[108:109], 0
    ds_read_b64 v[110:111], v105 offset:11264
    s_add_u32 s13, s92, 45056
    buffer_load_dwordx4 v[252:255], v96, s[52:55], s13 offen sc1
    s_waitcnt lgkmcnt(3)
    v_smfmac_f32_32x32x32_bf16 v[136:151], v[120:123], v[152:159], v133
    s_mov_b64 exec, s[86:87]
    ds_read_b128 v[120:123], v132 offset:8960
    ds_read_b128 v[128:131], v132 offset:9600
    s_mov_b64 exec, -1
    s_waitcnt lgkmcnt(3)
    v_mfma_f32_32x32x16_bf16 v[168:183], v[116:119], v[112:115], v[168:183]
    ds_read_b128 v[116:119], v104 offset:10240
    s_add_u32 s13, s92, 81920
    buffer_load_dwordx4 v[200:203], v96, s[52:55], s13 offen sc1
    s_nop 5
    s_waitcnt vmcnt(8)
    v_smfmac_f32_32x32x32_bf16 v[136:151], v[124:127], v[160:167], v133
    s_setprio 0
    v_exp_f32 v168, v168
    v_exp_f32 v169, v169
    v_exp_f32 v170, v170
    v_exp_f32 v171, v171
    v_exp_f32 v172, v172
    v_exp_f32 v173, v173
    v_exp_f32 v174, v174
    v_exp_f32 v175, v175
    v_exp_f32 v176, v176
    v_exp_f32 v177, v177
    s_setprio 1
    v_exp_f32 v178, v178
    v_exp_f32 v179, v179
    v_exp_f32 v180, v180
    s_setprio 3
    v_mfma_f32_16x16x32_bf16 v[72:75], v[216:219], v[192:195], 0
    v_exp_f32 v181, v181
    v_mfma_f32_16x16x32_bf16 v[92:95], v[216:219], v[196:199], 0
    v_exp_f32 v182, v182
    v_mfma_f32_16x16x32_bf16 v[16:19], v[236:239], v[220:223], v[16:19]
    v_exp_f32 v183, v183
    s_setprio 2
    s_waitcnt lgkmcnt(3)
    v_mfma_f32_32x32x8_bf16 v[152:167], v[110:111], v[106:107], 0
    s_add_u32 s13, s92, 82944
    buffer_load_dwordx4 v[204:207], v96, s[52:55], s13 offen sc1
    s_waitcnt lgkmcnt(2)
    v_smfmac_f32_32x32x32_bf16 v[136:151], v[120:123], v[168:175], v133
    s_mov_b64 exec, s[86:87]
    ds_read_b128 v[120:123], v132 offset:11520
    ds_read_b128 v[124:127], v132 offset:12160
    s_mov_b64 exec, -1
    s_waitcnt lgkmcnt(2)
    v_mfma_f32_32x32x16_bf16 v[152:167], v[116:119], v[112:115], v[152:167]
    ds_read_b128 v[116:119], v104 offset:12800
    s_add_u32 s13, s92, 83968
    buffer_load_dwordx4 v[208:211], v96, s[52:55], s13 offen sc1
    s_nop 5
    s_waitcnt vmcnt(6)
    v_smfmac_f32_32x32x32_bf16 v[136:151], v[128:131], v[176:183], v133
    s_setprio 0
    v_exp_f32 v152, v152
    v_exp_f32 v153, v153
    v_exp_f32 v154, v154
    v_exp_f32 v155, v155
    v_exp_f32 v156, v156
    v_exp_f32 v157, v157
    v_exp_f32 v158, v158
    v_exp_f32 v159, v159
    v_exp_f32 v160, v160
    v_exp_f32 v161, v161
    s_setprio 1
    v_exp_f32 v162, v162
    v_exp_f32 v163, v163
    s_setprio 3
    v_mfma_f32_16x16x32_bf16 v[36:39], v[236:239], v[224:227], v[36:39]
    v_exp_f32 v164, v164
    v_mfma_f32_16x16x32_bf16 v[56:59], v[236:239], v[228:231], v[56:59]
    v_exp_f32 v165, v165
    v_mfma_f32_16x16x32_bf16 v[76:79], v[236:239], v[232:235], v[76:79]
    v_exp_f32 v166, v166
    v_mfma_f32_16x16x32_bf16 v[20:23], v[240:243], v[220:223], v[20:23]
    v_exp_f32 v167, v167
    s_setprio 2
    v_mfma_f32_32x32x8_bf16 v[168:183], v[110:111], v[108:109], 0
    ds_read_b64 v[110:111], v105 offset:16384
    s_add_u32 s13, s92, 84992
    buffer_load_dwordx4 v[212:215], v96, s[52:55], s13 offen sc1
    s_waitcnt lgkmcnt(3)
    v_smfmac_f32_32x32x32_bf16 v[136:151], v[120:123], v[152:159], v133
    s_mov_b64 exec, s[86:87]
    ds_read_b128 v[120:123], v132 offset:14080
    ds_read_b128 v[128:131], v132 offset:14720
    s_mov_b64 exec, -1
    s_waitcnt lgkmcnt(3)
    v_mfma_f32_32x32x16_bf16 v[168:183], v[116:119], v[112:115], v[168:183]
    ds_read_b128 v[116:119], v104 offset:15360
    s_add_u32 s13, s91, 4096
    buffer_load_dwordx4 v[184:187], v96, s[52:55], s13 offen sc1
    s_nop 6
    v_smfmac_f32_32x32x32_bf16 v[136:151], v[124:127], v[160:167], v133
    s_setprio 0
    v_exp_f32 v168, v168
    v_exp_f32 v169, v169
    v_exp_f32 v170, v170
    v_exp_f32 v171, v171
    v_exp_f32 v172, v172
    v_exp_f32 v173, v173
    v_exp_f32 v174, v174
    v_exp_f32 v175, v175
    v_exp_f32 v176, v176
    v_exp_f32 v177, v177
    s_setprio 1
    v_exp_f32 v178, v178
    v_exp_f32 v179, v179
    v_exp_f32 v180, v180
    s_setprio 3
    v_mfma_f32_16x16x32_bf16 v[40:43], v[240:243], v[224:227], v[40:43]
    v_exp_f32 v181, v181
    v_mfma_f32_16x16x32_bf16 v[60:63], v[240:243], v[228:231], v[60:63]
    v_exp_f32 v182, v182
    v_mfma_f32_16x16x32_bf16 v[80:83], v[240:243], v[232:235], v[80:83]
    v_exp_f32 v183, v183
    s_setprio 2
    s_waitcnt lgkmcnt(3)
    v_mfma_f32_32x32x8_bf16 v[152:167], v[110:111], v[106:107], 0
    s_add_u32 s13, s91, 5120
    buffer_load_dwordx4 v[188:191], v96, s[52:55], s13 offen sc1
    s_waitcnt lgkmcnt(2)
    v_smfmac_f32_32x32x32_bf16 v[136:151], v[120:123], v[168:175], v133
    s_mov_b64 exec, s[86:87]
    ds_read_b128 v[120:123], v132 offset:16640
    ds_read_b128 v[124:127], v132 offset:17280
    s_mov_b64 exec, -1
    s_waitcnt lgkmcnt(2)
    v_mfma_f32_32x32x16_bf16 v[152:167], v[116:119], v[112:115], v[152:167]
    ds_read_b128 v[116:119], v104 offset:17920
    s_add_u32 s13, s93, 4096
    buffer_load_dwordx4 v[192:195], v96, s[52:55], s13 offen sc1
    s_nop 5
    s_waitcnt vmcnt(9)
    v_smfmac_f32_32x32x32_bf16 v[136:151], v[128:131], v[176:183], v133
    s_setprio 0
    v_exp_f32 v152, v152
    v_exp_f32 v153, v153
    v_exp_f32 v154, v154
    v_exp_f32 v155, v155
    v_exp_f32 v156, v156
    v_exp_f32 v157, v157
    v_exp_f32 v158, v158
    v_exp_f32 v159, v159
    v_exp_f32 v160, v160
    v_exp_f32 v161, v161
    s_setprio 1
    v_exp_f32 v162, v162
    v_exp_f32 v163, v163
    s_setprio 3
    v_mfma_f32_16x16x32_bf16 v[24:27], v[244:247], v[220:223], v[24:27]
    v_exp_f32 v164, v164
    v_mfma_f32_16x16x32_bf16 v[44:47], v[244:247], v[224:227], v[44:47]
    v_exp_f32 v165, v165
    v_mfma_f32_16x16x32_bf16 v[64:67], v[244:247], v[228:231], v[64:67]
    v_exp_f32 v166, v166
    v_mfma_f32_16x16x32_bf16 v[84:87], v[244:247], v[232:235], v[84:87]
    v_exp_f32 v167, v167
    s_setprio 2
    v_mfma_f32_32x32x8_bf16 v[168:183], v[110:111], v[108:109], 0
    ds_read_b64 v[110:111], v105 offset:21504
    s_add_u32 s13, s92, 86016
    buffer_load_dwordx4 v[216:219], v96, s[52:55], s13 offen sc1
    s_waitcnt lgkmcnt(3)
    v_smfmac_f32_32x32x32_bf16 v[136:151], v[120:123], v[152:159], v133
    s_mov_b64 exec, s[86:87]
    ds_read_b128 v[120:123], v132 offset:19200
    ds_read_b128 v[128:131], v132 offset:19840
    s_mov_b64 exec, -1
    s_waitcnt lgkmcnt(3)
    v_mfma_f32_32x32x16_bf16 v[168:183], v[116:119], v[112:115], v[168:183]
    ds_read_b128 v[116:119], v104 offset:20480
    s_add_u32 s13, s93, 5120
    buffer_load_dwordx4 v[196:199], v96, s[52:55], s13 offen sc1
    s_nop 5
    s_waitcnt vmcnt(10)
    v_smfmac_f32_32x32x32_bf16 v[136:151], v[124:127], v[160:167], v133
    s_setprio 0
    v_exp_f32 v168, v168
    v_exp_f32 v169, v169
    v_exp_f32 v170, v170
    v_exp_f32 v171, v171
    v_exp_f32 v172, v172
    v_exp_f32 v173, v173
    v_exp_f32 v174, v174
    v_exp_f32 v175, v175
    v_exp_f32 v176, v176
    v_exp_f32 v177, v177
    s_setprio 1
    v_exp_f32 v178, v178
    v_exp_f32 v179, v179
    v_exp_f32 v180, v180
    s_setprio 3
    v_mfma_f32_16x16x32_bf16 v[28:31], v[248:251], v[220:223], v[28:31]
    v_exp_f32 v181, v181
    v_mfma_f32_16x16x32_bf16 v[48:51], v[248:251], v[224:227], v[48:51]
    v_exp_f32 v182, v182
    v_mfma_f32_16x16x32_bf16 v[68:71], v[248:251], v[228:231], v[68:71]
    v_exp_f32 v183, v183
    s_setprio 2
    s_waitcnt lgkmcnt(3)
    v_mfma_f32_32x32x8_bf16 v[152:167], v[110:111], v[106:107], 0
    s_add_u32 s13, s92, 122880
    buffer_load_dwordx4 v[236:239], v96, s[52:55], s13 offen sc1
    s_waitcnt lgkmcnt(2)
    v_smfmac_f32_32x32x32_bf16 v[136:151], v[120:123], v[168:175], v133
    s_mov_b64 exec, s[86:87]
    ds_read_b128 v[120:123], v132 offset:21760
    ds_read_b128 v[124:127], v132 offset:22400
    s_mov_b64 exec, -1
    s_waitcnt lgkmcnt(2)
    v_mfma_f32_32x32x16_bf16 v[152:167], v[116:119], v[112:115], v[152:167]
    ds_read_b128 v[116:119], v104 offset:23040
    s_add_u32 s13, s92, 123904
    buffer_load_dwordx4 v[240:243], v96, s[52:55], s13 offen sc1
    s_nop 5
    s_waitcnt vmcnt(11)
    v_smfmac_f32_32x32x32_bf16 v[136:151], v[128:131], v[176:183], v133
    s_setprio 0
    v_exp_f32 v152, v152
    v_exp_f32 v153, v153
    v_exp_f32 v154, v154
    v_exp_f32 v155, v155
    v_exp_f32 v156, v156
    v_exp_f32 v157, v157
    v_exp_f32 v158, v158
    v_exp_f32 v159, v159
    v_exp_f32 v160, v160
    v_exp_f32 v161, v161
    s_setprio 1
    v_exp_f32 v162, v162
    v_exp_f32 v163, v163
    s_setprio 3
    v_mfma_f32_16x16x32_bf16 v[88:91], v[248:251], v[232:235], v[88:91]
    v_exp_f32 v164, v164
    v_mfma_f32_16x16x32_bf16 v[32:35], v[252:255], v[220:223], v[32:35]
    v_exp_f32 v165, v165
    v_mfma_f32_16x16x32_bf16 v[52:55], v[252:255], v[224:227], v[52:55]
    v_exp_f32 v166, v166
    v_mfma_f32_16x16x32_bf16 v[72:75], v[252:255], v[228:231], v[72:75]
    v_exp_f32 v167, v167
    s_setprio 2
    v_mfma_f32_32x32x8_bf16 v[168:183], v[110:111], v[108:109], 0
    ds_read_b64 v[110:111], v105 offset:26624
    s_add_u32 s13, s92, 124928
    buffer_load_dwordx4 v[244:247], v96, s[52:55], s13 offen sc1
    s_waitcnt lgkmcnt(3)
    v_smfmac_f32_32x32x32_bf16 v[136:151], v[120:123], v[152:159], v133
    s_mov_b64 exec, s[86:87]
    ds_read_b128 v[120:123], v132 offset:24320
    ds_read_b128 v[128:131], v132 offset:24960
    s_mov_b64 exec, -1
    s_waitcnt lgkmcnt(3)
    v_mfma_f32_32x32x16_bf16 v[168:183], v[116:119], v[112:115], v[168:183]
    ds_read_b128 v[116:119], v104 offset:25600
    s_add_u32 s13, s92, 125952
    buffer_load_dwordx4 v[248:251], v96, s[52:55], s13 offen sc1
    s_nop 5
    s_waitcnt vmcnt(8)
    v_smfmac_f32_32x32x32_bf16 v[136:151], v[124:127], v[160:167], v133
    s_setprio 0
    v_exp_f32 v168, v168
    v_exp_f32 v169, v169
    v_exp_f32 v170, v170
    v_exp_f32 v171, v171
    v_exp_f32 v172, v172
    v_exp_f32 v173, v173
    v_exp_f32 v174, v174
    v_exp_f32 v175, v175
    v_exp_f32 v176, v176
    v_exp_f32 v177, v177
    s_setprio 1
    v_exp_f32 v178, v178
    v_exp_f32 v179, v179
    v_exp_f32 v180, v180
    s_setprio 3
    v_mfma_f32_16x16x32_bf16 v[92:95], v[252:255], v[232:235], v[92:95]
    v_exp_f32 v181, v181
    v_mfma_f32_16x16x32_bf16 v[16:19], v[200:203], v[184:187], v[16:19]
    v_exp_f32 v182, v182
    v_mfma_f32_16x16x32_bf16 v[20:23], v[204:207], v[184:187], v[20:23]
    v_exp_f32 v183, v183
    s_setprio 2
    s_waitcnt lgkmcnt(3)
    v_mfma_f32_32x32x8_bf16 v[152:167], v[110:111], v[106:107], 0
    s_add_u32 s13, s91, 6144
    buffer_load_dwordx4 v[220:223], v96, s[52:55], s13 offen sc1
    s_waitcnt lgkmcnt(2)
    v_smfmac_f32_32x32x32_bf16 v[136:151], v[120:123], v[168:175], v133
    s_mov_b64 exec, s[86:87]
    ds_read_b128 v[120:123], v132 offset:26880
    ds_read_b128 v[124:127], v132 offset:27520
    s_mov_b64 exec, -1
    s_waitcnt lgkmcnt(2)
    v_mfma_f32_32x32x16_bf16 v[152:167], v[116:119], v[112:115], v[152:167]
    ds_read_b128 v[116:119], v104 offset:28160
    s_add_u32 s13, s91, 7168
    buffer_load_dwordx4 v[224:227], v96, s[52:55], s13 offen sc1
    s_nop 5
    s_waitcnt vmcnt(7)
    v_smfmac_f32_32x32x32_bf16 v[136:151], v[128:131], v[176:183], v133
    s_setprio 0
    v_exp_f32 v152, v152
    v_exp_f32 v153, v153
    v_exp_f32 v154, v154
    v_exp_f32 v155, v155
    v_exp_f32 v156, v156
    v_exp_f32 v157, v157
    v_exp_f32 v158, v158
    v_exp_f32 v159, v159
    v_exp_f32 v160, v160
    v_exp_f32 v161, v161
    s_setprio 1
    v_exp_f32 v162, v162
    v_exp_f32 v163, v163
    s_setprio 3
    v_mfma_f32_16x16x32_bf16 v[24:27], v[208:211], v[184:187], v[24:27]
    v_exp_f32 v164, v164
    v_mfma_f32_16x16x32_bf16 v[28:31], v[212:215], v[184:187], v[28:31]
    v_exp_f32 v165, v165
    v_mfma_f32_16x16x32_bf16 v[32:35], v[216:219], v[184:187], v[32:35]
    v_exp_f32 v166, v166
    v_mfma_f32_16x16x32_bf16 v[36:39], v[200:203], v[188:191], v[36:39]
    v_exp_f32 v167, v167
    s_setprio 2
    v_mfma_f32_32x32x8_bf16 v[168:183], v[110:111], v[108:109], 0
    ds_read_b64 v[110:111], v105 offset:31744
    s_add_u32 s13, s93, 6144
    buffer_load_dwordx4 v[228:231], v96, s[52:55], s13 offen sc1
    s_waitcnt lgkmcnt(3)
    v_smfmac_f32_32x32x32_bf16 v[136:151], v[120:123], v[152:159], v133
    s_mov_b64 exec, s[86:87]
    ds_read_b128 v[120:123], v132 offset:29440
    ds_read_b128 v[128:131], v132 offset:30080
    s_mov_b64 exec, -1
    s_waitcnt lgkmcnt(3)
    v_mfma_f32_32x32x16_bf16 v[168:183], v[116:119], v[112:115], v[168:183]
    ds_read_b128 v[116:119], v104 offset:30720
    s_add_u32 s13, s92, 126976
    buffer_load_dwordx4 v[252:255], v96, s[52:55], s13 offen sc1
    s_nop 6
    v_smfmac_f32_32x32x32_bf16 v[136:151], v[124:127], v[160:167], v133
    s_setprio 0
    v_exp_f32 v168, v168
    v_exp_f32 v169, v169
    v_exp_f32 v170, v170
    v_exp_f32 v171, v171
    v_exp_f32 v172, v172
    v_exp_f32 v173, v173
    v_exp_f32 v174, v174
    v_exp_f32 v175, v175
    v_exp_f32 v176, v176
    v_exp_f32 v177, v177
    s_setprio 1
    v_exp_f32 v178, v178
    v_exp_f32 v179, v179
    v_exp_f32 v180, v180
    s_setprio 3
    v_mfma_f32_16x16x32_bf16 v[40:43], v[204:207], v[188:191], v[40:43]
    v_exp_f32 v181, v181
    v_mfma_f32_16x16x32_bf16 v[44:47], v[208:211], v[188:191], v[44:47]
    v_exp_f32 v182, v182
    v_mfma_f32_16x16x32_bf16 v[48:51], v[212:215], v[188:191], v[48:51]
    v_exp_f32 v183, v183
    s_setprio 2
    s_waitcnt lgkmcnt(3)
    v_mfma_f32_32x32x8_bf16 v[152:167], v[110:111], v[106:107], 0
    s_add_u32 s13, s93, 7168
    buffer_load_dwordx4 v[232:235], v96, s[52:55], s13 offen sc1
    s_waitcnt lgkmcnt(2)
    v_smfmac_f32_32x32x32_bf16 v[136:151], v[120:123], v[168:175], v133
    s_mov_b64 exec, s[86:87]
    ds_read_b128 v[120:123], v132 offset:32000
    ds_read_b128 v[124:127], v132 offset:32640
    s_mov_b64 exec, -1
    s_waitcnt lgkmcnt(2)
    v_mfma_f32_32x32x16_bf16 v[152:167], v[116:119], v[112:115], v[152:167]
    ds_read_b128 v[116:119], v104 offset:33280
    s_add_u32 s13, s91, 8192
    buffer_load_dwordx4 v[184:187], v96, s[52:55], s13 offen sc1
    s_nop 6
    v_smfmac_f32_32x32x32_bf16 v[136:151], v[128:131], v[176:183], v133
    s_setprio 0
    v_exp_f32 v152, v152
    v_exp_f32 v153, v153
    v_exp_f32 v154, v154
    v_exp_f32 v155, v155
    v_exp_f32 v156, v156
    v_exp_f32 v157, v157
    v_exp_f32 v158, v158
    v_exp_f32 v159, v159
    v_exp_f32 v160, v160
    v_exp_f32 v161, v161
    s_setprio 1
    v_exp_f32 v162, v162
    v_exp_f32 v163, v163
    s_setprio 3
    v_mfma_f32_16x16x32_bf16 v[52:55], v[216:219], v[188:191], v[52:55]
    v_exp_f32 v164, v164
    v_mfma_f32_16x16x32_bf16 v[56:59], v[200:203], v[192:195], v[56:59]
    v_exp_f32 v165, v165
    v_mfma_f32_16x16x32_bf16 v[60:63], v[204:207], v[192:195], v[60:63]
    v_exp_f32 v166, v166
    v_mfma_f32_16x16x32_bf16 v[64:67], v[208:211], v[192:195], v[64:67]
    v_exp_f32 v167, v167
    s_setprio 2
    v_mfma_f32_32x32x8_bf16 v[168:183], v[110:111], v[108:109], 0
    ds_read_b64 v[110:111], v105 offset:36864
    s_add_u32 s13, s91, 9216
    buffer_load_dwordx4 v[188:191], v96, s[52:55], s13 offen sc1
    s_waitcnt lgkmcnt(3)
    v_smfmac_f32_32x32x32_bf16 v[136:151], v[120:123], v[152:159], v133
    s_mov_b64 exec, s[86:87]
    ds_read_b128 v[120:123], v132 offset:34560
    ds_read_b128 v[128:131], v132 offset:35200
    s_mov_b64 exec, -1
    s_waitcnt lgkmcnt(3)
    v_mfma_f32_32x32x16_bf16 v[168:183], v[116:119], v[112:115], v[168:183]
    ds_read_b128 v[116:119], v104 offset:35840
    s_add_u32 s13, s94, 4096
    buffer_load_dwordx4 v[12:15], v96, s[52:55], s13 offen sc1
    s_nop 5
    s_waitcnt vmcnt(12)
    v_smfmac_f32_32x32x32_bf16 v[136:151], v[124:127], v[160:167], v133
    s_setprio 0
    v_exp_f32 v168, v168
    v_exp_f32 v169, v169
    v_exp_f32 v170, v170
    v_exp_f32 v171, v171
    v_exp_f32 v172, v172
    v_exp_f32 v173, v173
    v_exp_f32 v174, v174
    v_exp_f32 v175, v175
    v_exp_f32 v176, v176
    v_exp_f32 v177, v177
    s_setprio 1
    v_exp_f32 v178, v178
    v_exp_f32 v179, v179
    v_exp_f32 v180, v180
    s_setprio 3
    v_mfma_f32_16x16x32_bf16 v[68:71], v[212:215], v[192:195], v[68:71]
    v_exp_f32 v181, v181
    v_mfma_f32_16x16x32_bf16 v[72:75], v[216:219], v[192:195], v[72:75]
    v_exp_f32 v182, v182
    v_mfma_f32_16x16x32_bf16 v[76:79], v[200:203], v[196:199], v[76:79]
    v_exp_f32 v183, v183
    s_setprio 2
    s_waitcnt lgkmcnt(3)
    v_mfma_f32_32x32x8_bf16 v[152:167], v[110:111], v[106:107], 0
    s_add_u32 s13, s93, 8192
    buffer_load_dwordx4 v[192:195], v96, s[52:55], s13 offen sc1
    s_waitcnt lgkmcnt(2)
    v_smfmac_f32_32x32x32_bf16 v[136:151], v[120:123], v[168:175], v133
    s_mov_b64 exec, s[86:87]
    ds_read_b128 v[120:123], v132 offset:37120
    ds_read_b128 v[124:127], v132 offset:37760
    s_mov_b64 exec, -1
    s_waitcnt lgkmcnt(2)
    v_mfma_f32_32x32x16_bf16 v[152:167], v[116:119], v[112:115], v[152:167]
    ds_read_b128 v[116:119], v104 offset:38400
    s_add_u32 s13, s92, 163840
    buffer_load_dwordx4 v[200:203], v96, s[52:55], s13 offen sc1
    s_nop 6
    v_smfmac_f32_32x32x32_bf16 v[136:151], v[128:131], v[176:183], v133
    s_setprio 0
    v_exp_f32 v152, v152
    v_exp_f32 v153, v153
    v_exp_f32 v154, v154
    v_exp_f32 v155, v155
    v_exp_f32 v156, v156
    v_exp_f32 v157, v157
    v_exp_f32 v158, v158
    v_exp_f32 v159, v159
    v_exp_f32 v160, v160
    v_exp_f32 v161, v161
    s_setprio 1
    v_exp_f32 v162, v162
    v_exp_f32 v163, v163
    s_setprio 3
    v_mfma_f32_16x16x32_bf16 v[80:83], v[204:207], v[196:199], v[80:83]
    v_exp_f32 v164, v164
    v_mfma_f32_16x16x32_bf16 v[84:87], v[208:211], v[196:199], v[84:87]
    v_exp_f32 v165, v165
    v_mfma_f32_16x16x32_bf16 v[88:91], v[212:215], v[196:199], v[88:91]
    v_exp_f32 v166, v166
    v_mfma_f32_16x16x32_bf16 v[92:95], v[216:219], v[196:199], v[92:95]
    v_exp_f32 v167, v167
    s_setprio 2
    v_mfma_f32_32x32x8_bf16 v[168:183], v[110:111], v[108:109], 0
    ds_read_b64 v[110:111], v105 offset:41984
    s_add_u32 s13, s92, 164864
    buffer_load_dwordx4 v[204:207], v96, s[52:55], s13 offen sc1
    s_waitcnt lgkmcnt(3)
    v_smfmac_f32_32x32x32_bf16 v[136:151], v[120:123], v[152:159], v133
    s_mov_b64 exec, s[86:87]
    ds_read_b128 v[120:123], v132 offset:39680
    ds_read_b128 v[128:131], v132 offset:40320
    s_mov_b64 exec, -1
    s_waitcnt lgkmcnt(3)
    v_mfma_f32_32x32x16_bf16 v[168:183], v[116:119], v[112:115], v[168:183]
    ds_read_b128 v[116:119], v104 offset:40960
    s_add_u32 s13, s92, 165888
    buffer_load_dwordx4 v[208:211], v96, s[52:55], s13 offen sc1
    s_nop 5
    s_waitcnt vmcnt(11)
    v_smfmac_f32_32x32x32_bf16 v[136:151], v[124:127], v[160:167], v133
    s_setprio 0
    v_exp_f32 v168, v168
    v_exp_f32 v169, v169
    v_exp_f32 v170, v170
    v_exp_f32 v171, v171
    v_exp_f32 v172, v172
    v_exp_f32 v173, v173
    v_exp_f32 v174, v174
    v_exp_f32 v175, v175
    v_exp_f32 v176, v176
    v_exp_f32 v177, v177
    s_setprio 1
    v_exp_f32 v178, v178
    v_exp_f32 v179, v179
    v_exp_f32 v180, v180
    s_setprio 3
    v_mfma_f32_16x16x32_bf16 v[16:19], v[236:239], v[220:223], v[16:19]
    v_exp_f32 v181, v181
    v_mfma_f32_16x16x32_bf16 v[20:23], v[240:243], v[220:223], v[20:23]
    v_exp_f32 v182, v182
    v_mfma_f32_16x16x32_bf16 v[24:27], v[244:247], v[220:223], v[24:27]
    v_exp_f32 v183, v183
    s_setprio 2
    s_waitcnt lgkmcnt(3)
    v_mfma_f32_32x32x8_bf16 v[152:167], v[110:111], v[106:107], 0
    s_add_u32 s13, s92, 166912
    buffer_load_dwordx4 v[212:215], v96, s[52:55], s13 offen sc1
    s_waitcnt lgkmcnt(2)
    v_smfmac_f32_32x32x32_bf16 v[136:151], v[120:123], v[168:175], v133
    s_mov_b64 exec, s[86:87]
    ds_read_b128 v[120:123], v132 offset:42240
    ds_read_b128 v[124:127], v132 offset:42880
    s_mov_b64 exec, -1
    s_waitcnt lgkmcnt(2)
    v_mfma_f32_32x32x16_bf16 v[152:167], v[116:119], v[112:115], v[152:167]
    ds_read_b128 v[116:119], v104 offset:43520
    s_add_u32 s13, s92, 167936
    buffer_load_dwordx4 v[216:219], v96, s[52:55], s13 offen sc1
    s_nop 5
    s_waitcnt vmcnt(10)
    v_smfmac_f32_32x32x32_bf16 v[136:151], v[128:131], v[176:183], v133
    s_setprio 0
    v_exp_f32 v152, v152
    v_exp_f32 v153, v153
    v_exp_f32 v154, v154
    v_exp_f32 v155, v155
    v_exp_f32 v156, v156
    v_exp_f32 v157, v157
    v_exp_f32 v158, v158
    v_exp_f32 v159, v159
    v_exp_f32 v160, v160
    v_exp_f32 v161, v161
    s_setprio 1
    v_exp_f32 v162, v162
    v_exp_f32 v163, v163
    s_setprio 3
    v_mfma_f32_16x16x32_bf16 v[28:31], v[248:251], v[220:223], v[28:31]
    v_exp_f32 v164, v164
    v_mfma_f32_16x16x32_bf16 v[32:35], v[252:255], v[220:223], v[32:35]
    v_exp_f32 v165, v165
    v_mfma_f32_16x16x32_bf16 v[36:39], v[236:239], v[224:227], v[36:39]
    v_exp_f32 v166, v166
    v_mfma_f32_16x16x32_bf16 v[40:43], v[240:243], v[224:227], v[40:43]
    v_exp_f32 v167, v167
    s_setprio 2
    v_mfma_f32_32x32x8_bf16 v[168:183], v[110:111], v[108:109], 0
    ds_read_b64 v[110:111], v105 offset:47104
    s_add_u32 s13, s93, 9216
    buffer_load_dwordx4 v[196:199], v96, s[52:55], s13 offen sc1
    s_waitcnt lgkmcnt(3)
    v_smfmac_f32_32x32x32_bf16 v[136:151], v[120:123], v[152:159], v133
    s_mov_b64 exec, s[86:87]
    ds_read_b128 v[120:123], v132 offset:44800
    ds_read_b128 v[128:131], v132 offset:45440
    s_mov_b64 exec, -1
    s_waitcnt lgkmcnt(3)
    v_mfma_f32_32x32x16_bf16 v[168:183], v[116:119], v[112:115], v[168:183]
    ds_read_b128 v[116:119], v104 offset:46080
    s_add_u32 s13, s91, 10240
    buffer_load_dwordx4 v[220:223], v96, s[52:55], s13 offen sc1
    s_nop 6
    v_smfmac_f32_32x32x32_bf16 v[136:151], v[124:127], v[160:167], v133
    s_setprio 0
    v_exp_f32 v168, v168
    v_exp_f32 v169, v169
    v_exp_f32 v170, v170
    v_exp_f32 v171, v171
    v_exp_f32 v172, v172
    v_exp_f32 v173, v173
    v_exp_f32 v174, v174
    v_exp_f32 v175, v175
    v_exp_f32 v176, v176
    v_exp_f32 v177, v177
    s_setprio 1
    v_exp_f32 v178, v178
    v_exp_f32 v179, v179
    v_exp_f32 v180, v180
    s_setprio 3
    v_mfma_f32_16x16x32_bf16 v[44:47], v[244:247], v[224:227], v[44:47]
    v_exp_f32 v181, v181
    v_mfma_f32_16x16x32_bf16 v[48:51], v[248:251], v[224:227], v[48:51]
    v_exp_f32 v182, v182
    v_mfma_f32_16x16x32_bf16 v[52:55], v[252:255], v[224:227], v[52:55]
    v_exp_f32 v183, v183
    s_setprio 2
    s_waitcnt lgkmcnt(3)
    v_mfma_f32_32x32x8_bf16 v[152:167], v[110:111], v[106:107], 0
    s_add_u32 s13, s91, 11264
    buffer_load_dwordx4 v[224:227], v96, s[52:55], s13 offen sc1
    s_waitcnt lgkmcnt(2)
    v_smfmac_f32_32x32x32_bf16 v[136:151], v[120:123], v[168:175], v133
    s_mov_b64 exec, s[86:87]
    ds_read_b128 v[120:123], v132 offset:47360
    ds_read_b128 v[124:127], v132 offset:48000
    s_mov_b64 exec, -1
    s_waitcnt lgkmcnt(2)
    v_mfma_f32_32x32x16_bf16 v[152:167], v[116:119], v[112:115], v[152:167]
    ds_read_b128 v[116:119], v104 offset:48640
    s_lshl_b32 s4, s4, 6
    s_add_u32 s4, s4, 32768
    buffer_load_dword v102, v99, s[52:55], s4 offen sc1
    s_nop 5
    v_smfmac_f32_32x32x32_bf16 v[136:151], v[128:131], v[176:183], v133
    s_setprio 0
    v_exp_f32 v152, v152
    v_exp_f32 v153, v153
    v_exp_f32 v154, v154
    v_exp_f32 v155, v155
    v_exp_f32 v156, v156
    v_exp_f32 v157, v157
    v_exp_f32 v158, v158
    v_exp_f32 v159, v159
    v_exp_f32 v160, v160
    v_exp_f32 v161, v161
    s_setprio 1
    v_exp_f32 v162, v162
    v_exp_f32 v163, v163
    s_setprio 3
    v_mfma_f32_16x16x32_bf16 v[56:59], v[236:239], v[228:231], v[56:59]
    v_exp_f32 v164, v164
    v_mfma_f32_16x16x32_bf16 v[60:63], v[240:243], v[228:231], v[60:63]
    v_exp_f32 v165, v165
    v_mfma_f32_16x16x32_bf16 v[64:67], v[244:247], v[228:231], v[64:67]
    v_exp_f32 v166, v166
    v_mfma_f32_16x16x32_bf16 v[68:71], v[248:251], v[228:231], v[68:71]
    v_exp_f32 v167, v167
    s_setprio 2
    v_mfma_f32_32x32x8_bf16 v[168:183], v[110:111], v[108:109], 0
    ds_read_b64 v[110:111], v105 offset:52224
    s_lshl_b32 s5, s5, 6
    s_add_u32 s5, s5, 32768
    buffer_load_dword v103, v99, s[52:55], s5 offen sc1
    s_waitcnt lgkmcnt(3)
    v_smfmac_f32_32x32x32_bf16 v[136:151], v[120:123], v[152:159], v133
    s_mov_b64 exec, s[86:87]
    ds_read_b128 v[120:123], v132 offset:49920
    ds_read_b128 v[128:131], v132 offset:50560
    s_mov_b64 exec, -1
    s_waitcnt lgkmcnt(3)
    v_mfma_f32_32x32x16_bf16 v[168:183], v[116:119], v[112:115], v[168:183]
    ds_read_b128 v[116:119], v104 offset:51200
    s_lshl_b32 s13, s81, 7
    s_add_u32 s13, s13, 32768
    buffer_load_dword v134, v98, s[52:55], s13 offen sc1
    s_nop 4
    s_waitcnt vmcnt(15)
    v_smfmac_f32_32x32x32_bf16 v[136:151], v[124:127], v[160:167], v133
    s_setprio 0
    v_exp_f32 v168, v168
    v_exp_f32 v169, v169
    v_exp_f32 v170, v170
    v_exp_f32 v171, v171
    v_exp_f32 v172, v172
    v_exp_f32 v173, v173
    v_exp_f32 v174, v174
    v_exp_f32 v175, v175
    v_exp_f32 v176, v176
    v_exp_f32 v177, v177
    s_setprio 1
    v_exp_f32 v178, v178
    v_exp_f32 v179, v179
    v_exp_f32 v180, v180
    s_setprio 3
    v_mfma_f32_16x16x32_bf16 v[72:75], v[252:255], v[228:231], v[72:75]
    v_exp_f32 v181, v181
    v_mfma_f32_16x16x32_bf16 v[76:79], v[236:239], v[232:235], v[76:79]
    v_exp_f32 v182, v182
    v_mfma_f32_16x16x32_bf16 v[80:83], v[240:243], v[232:235], v[80:83]
    v_exp_f32 v183, v183
    s_setprio 2
    s_waitcnt lgkmcnt(3)
    v_mfma_f32_32x32x8_bf16 v[152:167], v[110:111], v[106:107], 0
    s_add_u32 s13, s93, 10240
    buffer_load_dwordx4 v[228:231], v96, s[52:55], s13 offen sc1
    s_waitcnt lgkmcnt(2)
    v_smfmac_f32_32x32x32_bf16 v[136:151], v[120:123], v[168:175], v133
    s_mov_b64 exec, s[86:87]
    ds_read_b128 v[120:123], v132 offset:52480
    ds_read_b128 v[124:127], v132 offset:53120
    s_mov_b64 exec, -1
    s_waitcnt lgkmcnt(2)
    v_mfma_f32_32x32x16_bf16 v[152:167], v[116:119], v[112:115], v[152:167]
    ds_read_b128 v[116:119], v104 offset:53760
    s_add_u32 s13, s92, 204800
    buffer_load_dwordx4 v[236:239], v96, s[52:55], s13 offen sc1
    s_nop 5
    s_waitcnt vmcnt(12)
    v_smfmac_f32_32x32x32_bf16 v[136:151], v[128:131], v[176:183], v133
    s_setprio 0
    v_exp_f32 v152, v152
    v_exp_f32 v153, v153
    v_exp_f32 v154, v154
    v_exp_f32 v155, v155
    v_exp_f32 v156, v156
    v_exp_f32 v157, v157
    v_exp_f32 v158, v158
    v_exp_f32 v159, v159
    v_exp_f32 v160, v160
    v_exp_f32 v161, v161
    s_setprio 1
    v_exp_f32 v162, v162
    v_exp_f32 v163, v163
    s_setprio 3
    v_mfma_f32_16x16x32_bf16 v[84:87], v[244:247], v[232:235], v[84:87]
    v_exp_f32 v164, v164
    v_mfma_f32_16x16x32_bf16 v[88:91], v[248:251], v[232:235], v[88:91]
    v_exp_f32 v165, v165
    v_mfma_f32_16x16x32_bf16 v[92:95], v[252:255], v[232:235], v[92:95]
    v_exp_f32 v166, v166
    v_mfma_f32_16x16x32_bf16 v[16:19], v[200:203], v[184:187], v[16:19]
    v_exp_f32 v167, v167
    s_setprio 2
    v_mfma_f32_32x32x8_bf16 v[168:183], v[110:111], v[108:109], 0
    ds_read_b64 v[110:111], v105 offset:57344
    s_add_u32 s13, s92, 205824
    buffer_load_dwordx4 v[240:243], v96, s[52:55], s13 offen sc1
    s_waitcnt lgkmcnt(3)
    v_smfmac_f32_32x32x32_bf16 v[136:151], v[120:123], v[152:159], v133
    s_mov_b64 exec, s[86:87]
    ds_read_b128 v[120:123], v132 offset:55040
    ds_read_b128 v[128:131], v132 offset:55680
    s_mov_b64 exec, -1
    s_waitcnt lgkmcnt(3)
    v_mfma_f32_32x32x16_bf16 v[168:183], v[116:119], v[112:115], v[168:183]
    ds_read_b128 v[116:119], v104 offset:56320
    s_add_u32 s13, s92, 206848
    buffer_load_dwordx4 v[244:247], v96, s[52:55], s13 offen sc1
    s_nop 5
    s_waitcnt vmcnt(9)
    v_smfmac_f32_32x32x32_bf16 v[136:151], v[124:127], v[160:167], v133
    s_setprio 0
    v_exp_f32 v168, v168
    v_exp_f32 v169, v169
    v_exp_f32 v170, v170
    v_exp_f32 v171, v171
    v_exp_f32 v172, v172
    v_exp_f32 v173, v173
    v_exp_f32 v174, v174
    v_exp_f32 v175, v175
    v_exp_f32 v176, v176
    v_exp_f32 v177, v177
    s_setprio 1
    v_exp_f32 v178, v178
    v_exp_f32 v179, v179
    v_exp_f32 v180, v180
    s_setprio 3
    v_mfma_f32_16x16x32_bf16 v[36:39], v[200:203], v[188:191], v[36:39]
    v_exp_f32 v181, v181
    v_mfma_f32_16x16x32_bf16 v[56:59], v[200:203], v[192:195], v[56:59]
    v_exp_f32 v182, v182
    v_mfma_f32_16x16x32_bf16 v[76:79], v[200:203], v[196:199], v[76:79]
    v_exp_f32 v183, v183
    s_setprio 2
    s_waitcnt lgkmcnt(3)
    v_mfma_f32_32x32x8_bf16 v[152:167], v[110:111], v[106:107], 0
    s_add_u32 s13, s92, 207872
    buffer_load_dwordx4 v[248:251], v96, s[52:55], s13 offen sc1
    s_waitcnt lgkmcnt(2)
    v_smfmac_f32_32x32x32_bf16 v[136:151], v[120:123], v[168:175], v133
    s_mov_b64 exec, s[86:87]
    ds_read_b128 v[120:123], v132 offset:57600
    ds_read_b128 v[124:127], v132 offset:58240
    s_mov_b64 exec, -1
    s_waitcnt lgkmcnt(2)
    v_mfma_f32_32x32x16_bf16 v[152:167], v[116:119], v[112:115], v[152:167]
    ds_read_b128 v[116:119], v104 offset:58880
    s_add_u32 s13, s92, 208896
    buffer_load_dwordx4 v[252:255], v96, s[52:55], s13 offen sc1
    s_nop 6
    v_smfmac_f32_32x32x32_bf16 v[136:151], v[128:131], v[176:183], v133
    s_setprio 0
    v_exp_f32 v152, v152
    v_exp_f32 v153, v153
    v_exp_f32 v154, v154
    v_exp_f32 v155, v155
    v_exp_f32 v156, v156
    v_exp_f32 v157, v157
    v_exp_f32 v158, v158
    v_exp_f32 v159, v159
    v_exp_f32 v160, v160
    v_exp_f32 v161, v161
    s_setprio 1
    v_exp_f32 v162, v162
    v_exp_f32 v163, v163
    s_setprio 3
    v_mfma_f32_16x16x32_bf16 v[20:23], v[204:207], v[184:187], v[20:23]
    v_exp_f32 v164, v164
    v_mfma_f32_16x16x32_bf16 v[40:43], v[204:207], v[188:191], v[40:43]
    v_exp_f32 v165, v165
    v_mfma_f32_16x16x32_bf16 v[60:63], v[204:207], v[192:195], v[60:63]
    v_exp_f32 v166, v166
    v_mfma_f32_16x16x32_bf16 v[80:83], v[204:207], v[196:199], v[80:83]
    v_exp_f32 v167, v167
    s_setprio 2
    v_mfma_f32_32x32x8_bf16 v[168:183], v[110:111], v[108:109], 0
    ds_read_b64 v[110:111], v105 offset:62464
    s_add_u32 s13, s93, 11264
    buffer_load_dwordx4 v[232:235], v96, s[52:55], s13 offen sc1
    s_waitcnt lgkmcnt(3)
    v_smfmac_f32_32x32x32_bf16 v[136:151], v[120:123], v[152:159], v133
    s_mov_b64 exec, s[86:87]
    ds_read_b128 v[120:123], v132 offset:60160
    ds_read_b128 v[128:131], v132 offset:60800
    s_mov_b64 exec, -1
    s_waitcnt lgkmcnt(3)
    v_mfma_f32_32x32x16_bf16 v[168:183], v[116:119], v[112:115], v[168:183]
    ds_read_b128 v[116:119], v104 offset:61440
    s_add_u32 s13, s92, 245760
    buffer_load_dwordx4 v[200:203], v96, s[52:55], s13 offen sc1
    s_nop 6
    v_smfmac_f32_32x32x32_bf16 v[136:151], v[124:127], v[160:167], v133
    s_setprio 0
    v_exp_f32 v168, v168
    v_exp_f32 v169, v169
    v_exp_f32 v170, v170
    v_exp_f32 v171, v171
    v_exp_f32 v172, v172
    v_exp_f32 v173, v173
    v_exp_f32 v174, v174
    v_exp_f32 v175, v175
    v_exp_f32 v176, v176
    v_exp_f32 v177, v177
    s_setprio 1
    v_exp_f32 v178, v178
    v_exp_f32 v179, v179
    v_exp_f32 v180, v180
    s_setprio 3
    v_mfma_f32_16x16x32_bf16 v[24:27], v[208:211], v[184:187], v[24:27]
    v_exp_f32 v181, v181
    v_mfma_f32_16x16x32_bf16 v[44:47], v[208:211], v[188:191], v[44:47]
    v_exp_f32 v182, v182
    v_mfma_f32_16x16x32_bf16 v[64:67], v[208:211], v[192:195], v[64:67]
    v_exp_f32 v183, v183
    s_setprio 2
    s_waitcnt lgkmcnt(3)
    v_mfma_f32_32x32x8_bf16 v[152:167], v[110:111], v[106:107], 0
    s_add_u32 s13, s92, 246784
    buffer_load_dwordx4 v[204:207], v96, s[52:55], s13 offen sc1
    s_waitcnt lgkmcnt(2)
    v_smfmac_f32_32x32x32_bf16 v[136:151], v[120:123], v[168:175], v133
    s_mov_b64 exec, s[86:87]
    ds_read_b128 v[120:123], v132 offset:62720
    ds_read_b128 v[124:127], v132 offset:63360
    s_mov_b64 exec, -1
    s_waitcnt lgkmcnt(2)
    v_mfma_f32_32x32x16_bf16 v[152:167], v[116:119], v[112:115], v[152:167]
    v_add_u32 v104, 61440, v104
    ds_read_b128 v[116:119], v104 offset:2560
    s_xor_b32 s13, s84, 0
    s_lshl_b32 s13, s13, 7
    s_add_u32 s13, s13, 32768
    buffer_load_dword v8, v99, s[52:55], s13 offen sc1
    s_nop 3
    v_smfmac_f32_32x32x32_bf16 v[136:151], v[128:131], v[176:183], v133
    s_setprio 0
    v_exp_f32 v152, v152
    v_exp_f32 v153, v153
    v_exp_f32 v154, v154
    v_exp_f32 v155, v155
    v_exp_f32 v156, v156
    v_exp_f32 v157, v157
    v_exp_f32 v158, v158
    v_exp_f32 v159, v159
    v_exp_f32 v160, v160
    v_exp_f32 v161, v161
    s_setprio 1
    v_exp_f32 v162, v162
    v_exp_f32 v163, v163
    s_setprio 3
    v_mfma_f32_16x16x32_bf16 v[84:87], v[208:211], v[196:199], v[84:87]
    v_exp_f32 v164, v164
    v_mfma_f32_16x16x32_bf16 v[28:31], v[212:215], v[184:187], v[28:31]
    v_exp_f32 v165, v165
    v_mfma_f32_16x16x32_bf16 v[48:51], v[212:215], v[188:191], v[48:51]
    v_exp_f32 v166, v166
    v_mfma_f32_16x16x32_bf16 v[68:71], v[212:215], v[192:195], v[68:71]
    v_exp_f32 v167, v167
    s_setprio 2
    v_mfma_f32_32x32x8_bf16 v[168:183], v[110:111], v[108:109], 0
    v_add_u32 v105, 61440, v105
    ds_read_b64 v[110:111], v105 offset:6144
    s_add_u32 s13, s92, 247808
    buffer_load_dwordx4 v[208:211], v96, s[52:55], s13 offen sc1
    s_waitcnt lgkmcnt(3)
    v_smfmac_f32_32x32x32_bf16 v[136:151], v[120:123], v[152:159], v133
    v_add_u32 v132, 61440, v132
    s_mov_b64 exec, s[86:87]
    ds_read_b128 v[120:123], v132 offset:3840
    ds_read_b128 v[128:131], v132 offset:4480
    s_mov_b64 exec, -1
    s_waitcnt lgkmcnt(3)
    v_mfma_f32_32x32x16_bf16 v[168:183], v[116:119], v[112:115], v[168:183]
    ds_read_b128 v[116:119], v104 offset:5120
    s_xor_b32 s13, s84, 0
    s_lshl_b32 s13, s13, 7
    s_add_u32 s13, s13, 32832
    buffer_load_dword v9, v99, s[52:55], s13 offen sc1
    s_nop 4
    v_smfmac_f32_32x32x32_bf16 v[136:151], v[124:127], v[160:167], v133
    s_setprio 0
    v_exp_f32 v168, v168
    v_exp_f32 v169, v169
    v_exp_f32 v170, v170
    v_exp_f32 v171, v171
    v_exp_f32 v172, v172
    v_exp_f32 v173, v173
    v_exp_f32 v174, v174
    v_exp_f32 v175, v175
    v_exp_f32 v176, v176
    v_exp_f32 v177, v177
    s_setprio 1
    v_exp_f32 v178, v178
    v_exp_f32 v179, v179
    v_exp_f32 v180, v180
    s_setprio 3
    v_mfma_f32_16x16x32_bf16 v[88:91], v[212:215], v[196:199], v[88:91]
    v_exp_f32 v181, v181
    v_mfma_f32_16x16x32_bf16 v[32:35], v[216:219], v[184:187], v[32:35]
    v_exp_f32 v182, v182
    v_mfma_f32_16x16x32_bf16 v[52:55], v[216:219], v[188:191], v[52:55]
    v_exp_f32 v183, v183
    s_setprio 2
    s_waitcnt lgkmcnt(3)
    v_mfma_f32_32x32x8_bf16 v[152:167], v[110:111], v[106:107], 0
    s_add_u32 s13, s92, 248832
    buffer_load_dwordx4 v[212:215], v96, s[52:55], s13 offen sc1
    s_waitcnt lgkmcnt(2)
    v_smfmac_f32_32x32x32_bf16 v[136:151], v[120:123], v[168:175], v133
    s_mov_b64 exec, s[86:87]
    ds_read_b128 v[120:123], v132 offset:6400
    ds_read_b128 v[124:127], v132 offset:7040
    s_mov_b64 exec, -1
    s_waitcnt lgkmcnt(2)
    v_mfma_f32_32x32x16_bf16 v[152:167], v[116:119], v[112:115], v[152:167]
    ds_read_b128 v[116:119], v104 offset:7680
    s_add_u32 s13, s91, 12288
    buffer_load_dwordx4 v[184:187], v96, s[52:55], s13 offen sc1
    s_nop 5
    s_waitcnt vmcnt(12)
    v_smfmac_f32_32x32x32_bf16 v[136:151], v[128:131], v[176:183], v133
    s_setprio 0
    v_exp_f32 v152, v152
    v_exp_f32 v153, v153
    v_exp_f32 v154, v154
    v_exp_f32 v155, v155
    v_exp_f32 v156, v156
    v_exp_f32 v157, v157
    v_exp_f32 v158, v158
    v_exp_f32 v159, v159
    v_exp_f32 v160, v160
    v_exp_f32 v161, v161
    s_setprio 1
    v_exp_f32 v162, v162
    v_exp_f32 v163, v163
    s_setprio 3
    v_mfma_f32_16x16x32_bf16 v[72:75], v[216:219], v[192:195], v[72:75]
    v_exp_f32 v164, v164
    v_mfma_f32_16x16x32_bf16 v[92:95], v[216:219], v[196:199], v[92:95]
    v_exp_f32 v165, v165
    v_mfma_f32_16x16x32_bf16 v[16:19], v[236:239], v[220:223], v[16:19]
    v_exp_f32 v166, v166
    v_mfma_f32_16x16x32_bf16 v[36:39], v[236:239], v[224:227], v[36:39]
    v_exp_f32 v167, v167
    s_setprio 2
    v_mfma_f32_32x32x8_bf16 v[168:183], v[110:111], v[108:109], 0
    ds_read_b64 v[110:111], v105 offset:11264
    s_add_u32 s13, s91, 13312
    buffer_load_dwordx4 v[188:191], v96, s[52:55], s13 offen sc1
    s_waitcnt lgkmcnt(3)
    v_smfmac_f32_32x32x32_bf16 v[136:151], v[120:123], v[152:159], v133
    s_mov_b64 exec, s[86:87]
    ds_read_b128 v[120:123], v132 offset:8960
    ds_read_b128 v[128:131], v132 offset:9600
    s_mov_b64 exec, -1
    s_waitcnt lgkmcnt(3)
    v_mfma_f32_32x32x16_bf16 v[168:183], v[116:119], v[112:115], v[168:183]
    ds_read_b128 v[116:119], v104 offset:10240
    s_add_u32 s13, s93, 12288
    buffer_load_dwordx4 v[192:195], v96, s[52:55], s13 offen sc1
    s_nop 5
    s_waitcnt vmcnt(9)
    v_smfmac_f32_32x32x32_bf16 v[136:151], v[124:127], v[160:167], v133
    s_setprio 0
    v_exp_f32 v168, v168
    v_exp_f32 v169, v169
    v_exp_f32 v170, v170
    v_exp_f32 v171, v171
    v_exp_f32 v172, v172
    v_exp_f32 v173, v173
    v_exp_f32 v174, v174
    v_exp_f32 v175, v175
    v_exp_f32 v176, v176
    v_exp_f32 v177, v177
    s_setprio 1
    v_exp_f32 v178, v178
    v_exp_f32 v179, v179
    v_exp_f32 v180, v180
    s_setprio 3
    v_mfma_f32_16x16x32_bf16 v[56:59], v[236:239], v[228:231], v[56:59]
    v_exp_f32 v181, v181
    v_mfma_f32_16x16x32_bf16 v[76:79], v[236:239], v[232:235], v[76:79]
    v_exp_f32 v182, v182
    v_mfma_f32_16x16x32_bf16 v[20:23], v[240:243], v[220:223], v[20:23]
    v_exp_f32 v183, v183
    s_setprio 2
    s_waitcnt lgkmcnt(3)
    v_mfma_f32_32x32x8_bf16 v[152:167], v[110:111], v[106:107], 0
    s_add_u32 s13, s92, 249856
    buffer_load_dwordx4 v[216:219], v96, s[52:55], s13 offen sc1
    s_waitcnt lgkmcnt(2)
    v_smfmac_f32_32x32x32_bf16 v[136:151], v[120:123], v[168:175], v133
    s_mov_b64 exec, s[86:87]
    ds_read_b128 v[120:123], v132 offset:11520
    ds_read_b128 v[124:127], v132 offset:12160
    s_mov_b64 exec, -1
    s_waitcnt lgkmcnt(2)
    v_mfma_f32_32x32x16_bf16 v[152:167], v[116:119], v[112:115], v[152:167]
    ds_read_b128 v[116:119], v104 offset:12800
    s_add_u32 s13, s93, 13312
    buffer_load_dwordx4 v[196:199], v96, s[52:55], s13 offen sc1
    s_nop 6
    v_smfmac_f32_32x32x32_bf16 v[136:151], v[128:131], v[176:183], v133
    s_setprio 0
    v_exp_f32 v152, v152
    v_exp_f32 v153, v153
    v_exp_f32 v154, v154
    v_exp_f32 v155, v155
    v_exp_f32 v156, v156
    v_exp_f32 v157, v157
    v_exp_f32 v158, v158
    v_exp_f32 v159, v159
    v_exp_f32 v160, v160
    v_exp_f32 v161, v161
    s_setprio 1
    v_exp_f32 v162, v162
    v_exp_f32 v163, v163
    s_setprio 3
    v_mfma_f32_16x16x32_bf16 v[40:43], v[240:243], v[224:227], v[40:43]
    v_exp_f32 v164, v164
    v_mfma_f32_16x16x32_bf16 v[60:63], v[240:243], v[228:231], v[60:63]
    v_exp_f32 v165, v165
    v_mfma_f32_16x16x32_bf16 v[80:83], v[240:243], v[232:235], v[80:83]
    v_exp_f32 v166, v166
    v_mfma_f32_16x16x32_bf16 v[24:27], v[244:247], v[220:223], v[24:27]
    v_exp_f32 v167, v167
    s_setprio 2
    v_mfma_f32_32x32x8_bf16 v[168:183], v[110:111], v[108:109], 0
    ds_read_b64 v[110:111], v105 offset:16384
    s_add_u32 s13, s88, 0
    buffer_load_dwordx4 v[236:239], v96, s[52:55], s13 offen sc1
    s_waitcnt lgkmcnt(3)
    v_smfmac_f32_32x32x32_bf16 v[136:151], v[120:123], v[152:159], v133
    s_mov_b64 exec, s[86:87]
    ds_read_b128 v[120:123], v132 offset:14080
    ds_read_b128 v[128:131], v132 offset:14720
    s_mov_b64 exec, -1
    s_waitcnt lgkmcnt(3)
    v_mfma_f32_32x32x16_bf16 v[168:183], v[116:119], v[112:115], v[168:183]
    ds_read_b128 v[116:119], v104 offset:15360
    s_add_u32 s13, s88, 1024
    buffer_load_dwordx4 v[240:243], v96, s[52:55], s13 offen sc1
    s_nop 6
    v_smfmac_f32_32x32x32_bf16 v[136:151], v[124:127], v[160:167], v133
    s_setprio 0
    v_exp_f32 v168, v168
    v_exp_f32 v169, v169
    v_exp_f32 v170, v170
    v_exp_f32 v171, v171
    v_exp_f32 v172, v172
    v_exp_f32 v173, v173
    v_exp_f32 v174, v174
    v_exp_f32 v175, v175
    v_exp_f32 v176, v176
    v_exp_f32 v177, v177
    s_setprio 1
    v_exp_f32 v178, v178
    v_exp_f32 v179, v179
    v_exp_f32 v180, v180
    s_setprio 3
    v_mfma_f32_16x16x32_bf16 v[44:47], v[244:247], v[224:227], v[44:47]
    v_exp_f32 v181, v181
    v_mfma_f32_16x16x32_bf16 v[64:67], v[244:247], v[228:231], v[64:67]
    v_exp_f32 v182, v182
    v_mfma_f32_16x16x32_bf16 v[84:87], v[244:247], v[232:235], v[84:87]
    v_exp_f32 v183, v183
    s_setprio 2
    s_waitcnt lgkmcnt(3)
    v_mfma_f32_32x32x8_bf16 v[152:167], v[110:111], v[106:107], 0
    s_add_u32 s13, s88, 2048
    buffer_load_dwordx4 v[244:247], v96, s[52:55], s13 offen sc1
    s_waitcnt lgkmcnt(2)
    v_smfmac_f32_32x32x32_bf16 v[136:151], v[120:123], v[168:175], v133
    s_mov_b64 exec, s[86:87]
    ds_read_b128 v[120:123], v132 offset:16640
    ds_read_b128 v[124:127], v132 offset:17280
    s_mov_b64 exec, -1
    s_waitcnt lgkmcnt(2)
    v_mfma_f32_32x32x16_bf16 v[152:167], v[116:119], v[112:115], v[152:167]
    ds_read_b128 v[116:119], v104 offset:17920
    s_xor_b32 s13, s84, 1
    s_lshl_b32 s13, s13, 7
    s_add_u32 s13, s13, 32768
    buffer_load_dword v10, v99, s[52:55], s13 offen sc1
    s_nop 4
    v_smfmac_f32_32x32x32_bf16 v[136:151], v[128:131], v[176:183], v133
    s_setprio 0
    v_exp_f32 v152, v152
    v_exp_f32 v153, v153
    v_exp_f32 v154, v154
    v_exp_f32 v155, v155
    v_exp_f32 v156, v156
    v_exp_f32 v157, v157
    v_exp_f32 v158, v158
    v_exp_f32 v159, v159
    v_exp_f32 v160, v160
    v_exp_f32 v161, v161
    s_setprio 1
    v_exp_f32 v162, v162
    v_exp_f32 v163, v163
    s_setprio 3
    v_mfma_f32_16x16x32_bf16 v[28:31], v[248:251], v[220:223], v[28:31]
    v_exp_f32 v164, v164
    v_mfma_f32_16x16x32_bf16 v[48:51], v[248:251], v[224:227], v[48:51]
    v_exp_f32 v165, v165
    v_mfma_f32_16x16x32_bf16 v[68:71], v[248:251], v[228:231], v[68:71]
    v_exp_f32 v166, v166
    v_mfma_f32_16x16x32_bf16 v[88:91], v[248:251], v[232:235], v[88:91]
    v_exp_f32 v167, v167
    s_setprio 2
    v_mfma_f32_32x32x8_bf16 v[168:183], v[110:111], v[108:109], 0
    ds_read_b64 v[110:111], v105 offset:21504
    s_add_u32 s13, s88, 3072
    buffer_load_dwordx4 v[248:251], v96, s[52:55], s13 offen sc1
    s_waitcnt lgkmcnt(3)
    v_smfmac_f32_32x32x32_bf16 v[136:151], v[120:123], v[152:159], v133
    s_mov_b64 exec, s[86:87]
    ds_read_b128 v[120:123], v132 offset:19200
    ds_read_b128 v[128:131], v132 offset:19840
    s_mov_b64 exec, -1
    s_waitcnt lgkmcnt(3)
    v_mfma_f32_32x32x16_bf16 v[168:183], v[116:119], v[112:115], v[168:183]
    ds_read_b128 v[116:119], v104 offset:20480
    s_xor_b32 s13, s84, 1
    s_lshl_b32 s13, s13, 7
    s_add_u32 s13, s13, 32832
    buffer_load_dword v11, v99, s[52:55], s13 offen sc1
    s_nop 4
    v_smfmac_f32_32x32x32_bf16 v[136:151], v[124:127], v[160:167], v133
    s_setprio 0
    v_exp_f32 v168, v168
    v_exp_f32 v169, v169
    v_exp_f32 v170, v170
    v_exp_f32 v171, v171
    v_exp_f32 v172, v172
    v_exp_f32 v173, v173
    v_exp_f32 v174, v174
    v_exp_f32 v175, v175
    v_exp_f32 v176, v176
    v_exp_f32 v177, v177
    s_setprio 1
    v_exp_f32 v178, v178
    v_exp_f32 v179, v179
    v_exp_f32 v180, v180
    s_setprio 3
    v_mfma_f32_16x16x32_bf16 v[32:35], v[252:255], v[220:223], v[32:35]
    v_exp_f32 v181, v181
    v_mfma_f32_16x16x32_bf16 v[52:55], v[252:255], v[224:227], v[52:55]
    v_exp_f32 v182, v182
    v_mfma_f32_16x16x32_bf16 v[72:75], v[252:255], v[228:231], v[72:75]
    v_exp_f32 v183, v183
    s_setprio 2
    s_waitcnt lgkmcnt(3)
    v_mfma_f32_32x32x8_bf16 v[152:167], v[110:111], v[106:107], 0
    s_add_u32 s13, s94, 0
    buffer_load_dwordx4 v[220:223], v96, s[52:55], s13 offen sc1
    s_waitcnt lgkmcnt(2)
    v_smfmac_f32_32x32x32_bf16 v[136:151], v[120:123], v[168:175], v133
    s_mov_b64 exec, s[86:87]
    ds_read_b128 v[120:123], v132 offset:21760
    ds_read_b128 v[124:127], v132 offset:22400
    s_mov_b64 exec, -1
    s_waitcnt lgkmcnt(2)
    v_mfma_f32_32x32x16_bf16 v[152:167], v[116:119], v[112:115], v[152:167]
    ds_read_b128 v[116:119], v104 offset:23040
    s_add_u32 s13, s94, 1024
    buffer_load_dwordx4 v[224:227], v96, s[52:55], s13 offen sc1
    s_nop 5
    s_waitcnt vmcnt(12)
    v_smfmac_f32_32x32x32_bf16 v[136:151], v[128:131], v[176:183], v133
    s_setprio 0
    v_exp_f32 v152, v152
    v_exp_f32 v153, v153
    v_exp_f32 v154, v154
    v_exp_f32 v155, v155
    v_exp_f32 v156, v156
    v_exp_f32 v157, v157
    v_exp_f32 v158, v158
    v_exp_f32 v159, v159
    v_exp_f32 v160, v160
    v_exp_f32 v161, v161
    s_setprio 1
    v_exp_f32 v162, v162
    v_exp_f32 v163, v163
    s_setprio 3
    v_mfma_f32_16x16x32_bf16 v[92:95], v[252:255], v[232:235], v[92:95]
    v_exp_f32 v164, v164
    v_mfma_f32_16x16x32_bf16 v[16:19], v[200:203], v[184:187], v[16:19]
    v_exp_f32 v165, v165
    v_mfma_f32_16x16x32_bf16 v[20:23], v[204:207], v[184:187], v[20:23]
    v_exp_f32 v166, v166
    v_mfma_f32_16x16x32_bf16 v[24:27], v[208:211], v[184:187], v[24:27]
    v_exp_f32 v167, v167
    s_setprio 2
    v_mfma_f32_32x32x8_bf16 v[168:183], v[110:111], v[108:109], 0
    ds_read_b64 v[110:111], v105 offset:26624
    s_add_u32 s13, s94, 2048
    buffer_load_dwordx4 v[228:231], v96, s[52:55], s13 offen sc1
    s_waitcnt lgkmcnt(3)
    v_smfmac_f32_32x32x32_bf16 v[136:151], v[120:123], v[152:159], v133
    s_mov_b64 exec, s[86:87]
    ds_read_b128 v[120:123], v132 offset:24320
    ds_read_b128 v[128:131], v132 offset:24960
    s_mov_b64 exec, -1
    s_waitcnt lgkmcnt(3)
    v_mfma_f32_32x32x16_bf16 v[168:183], v[116:119], v[112:115], v[168:183]
    ds_read_b128 v[116:119], v104 offset:25600
    s_add_u32 s13, s88, 4096
    buffer_load_dwordx4 v[252:255], v96, s[52:55], s13 offen sc1
    s_nop 5
    s_waitcnt vmcnt(11)
    v_smfmac_f32_32x32x32_bf16 v[136:151], v[124:127], v[160:167], v133
    s_setprio 0
    v_exp_f32 v168, v168
    v_exp_f32 v169, v169
    v_exp_f32 v170, v170
    v_exp_f32 v171, v171
    v_exp_f32 v172, v172
    v_exp_f32 v173, v173
    v_exp_f32 v174, v174
    v_exp_f32 v175, v175
    v_exp_f32 v176, v176
    v_exp_f32 v177, v177
    s_setprio 1
    v_exp_f32 v178, v178
    v_exp_f32 v179, v179
    v_exp_f32 v180, v180
    s_setprio 3
    v_mfma_f32_16x16x32_bf16 v[28:31], v[212:215], v[184:187], v[28:31]
    v_exp_f32 v181, v181
    v_mfma_f32_16x16x32_bf16 v[32:35], v[216:219], v[184:187], v[32:35]
    v_exp_f32 v182, v182
    v_mfma_f32_16x16x32_bf16 v[36:39], v[200:203], v[188:191], v[36:39]
    v_exp_f32 v183, v183
    s_setprio 2
    s_waitcnt lgkmcnt(3)
    v_mfma_f32_32x32x8_bf16 v[152:167], v[110:111], v[106:107], 0
    s_add_u32 s13, s94, 3072
    buffer_load_dwordx4 v[232:235], v96, s[52:55], s13 offen sc1
    s_waitcnt lgkmcnt(2)
    v_smfmac_f32_32x32x32_bf16 v[136:151], v[120:123], v[168:175], v133
    s_mov_b64 exec, s[86:87]
    ds_read_b128 v[120:123], v132 offset:26880
    ds_read_b128 v[124:127], v132 offset:27520
    s_mov_b64 exec, -1
    s_waitcnt lgkmcnt(2)
    v_mfma_f32_32x32x16_bf16 v[152:167], v[116:119], v[112:115], v[152:167]
    ds_read_b128 v[116:119], v104 offset:28160
    s_nop 8
    v_smfmac_f32_32x32x32_bf16 v[136:151], v[128:131], v[176:183], v133
    s_setprio 0
    v_exp_f32 v152, v152
    v_exp_f32 v153, v153
    v_exp_f32 v154, v154
    v_exp_f32 v155, v155
    v_exp_f32 v156, v156
    v_exp_f32 v157, v157
    v_exp_f32 v158, v158
    v_exp_f32 v159, v159
    v_exp_f32 v160, v160
    v_exp_f32 v161, v161
    s_setprio 1
    v_exp_f32 v162, v162
    v_exp_f32 v163, v163
    s_setprio 3
    v_mfma_f32_16x16x32_bf16 v[40:43], v[204:207], v[188:191], v[40:43]
    v_exp_f32 v164, v164
    v_mfma_f32_16x16x32_bf16 v[44:47], v[208:211], v[188:191], v[44:47]
    v_exp_f32 v165, v165
    v_mfma_f32_16x16x32_bf16 v[48:51], v[212:215], v[188:191], v[48:51]
    v_exp_f32 v166, v166
    v_mfma_f32_16x16x32_bf16 v[52:55], v[216:219], v[188:191], v[52:55]
    v_exp_f32 v167, v167
    s_setprio 2
    v_mfma_f32_32x32x8_bf16 v[168:183], v[110:111], v[108:109], 0
    ds_read_b64 v[110:111], v105 offset:31744
    s_waitcnt lgkmcnt(3)
    v_smfmac_f32_32x32x32_bf16 v[136:151], v[120:123], v[152:159], v133
    s_mov_b64 exec, s[86:87]
    ds_read_b128 v[120:123], v132 offset:29440
    ds_read_b128 v[128:131], v132 offset:30080
    s_mov_b64 exec, -1
    s_waitcnt lgkmcnt(3)
    v_mfma_f32_32x32x16_bf16 v[168:183], v[116:119], v[112:115], v[168:183]
    ds_read_b128 v[116:119], v104 offset:30720
    s_nop 8
    v_smfmac_f32_32x32x32_bf16 v[136:151], v[124:127], v[160:167], v133
    s_setprio 0
    v_exp_f32 v168, v168
    v_exp_f32 v169, v169
    v_exp_f32 v170, v170
    v_exp_f32 v171, v171
    v_exp_f32 v172, v172
    v_exp_f32 v173, v173
    v_exp_f32 v174, v174
    v_exp_f32 v175, v175
    v_exp_f32 v176, v176
    v_exp_f32 v177, v177
    s_setprio 1
    v_exp_f32 v178, v178
    v_exp_f32 v179, v179
    v_exp_f32 v180, v180
    s_setprio 3
    v_mfma_f32_16x16x32_bf16 v[56:59], v[200:203], v[192:195], v[56:59]
    v_exp_f32 v181, v181
    v_mfma_f32_16x16x32_bf16 v[60:63], v[204:207], v[192:195], v[60:63]
    v_exp_f32 v182, v182
    v_mfma_f32_16x16x32_bf16 v[64:67], v[208:211], v[192:195], v[64:67]
    v_exp_f32 v183, v183
    s_setprio 2
    s_waitcnt lgkmcnt(3)
    v_mfma_f32_32x32x8_bf16 v[152:167], v[110:111], v[106:107], 0
    s_waitcnt lgkmcnt(2)
    v_smfmac_f32_32x32x32_bf16 v[136:151], v[120:123], v[168:175], v133
    s_mov_b64 exec, s[86:87]
    ds_read_b128 v[120:123], v132 offset:32000
    ds_read_b128 v[124:127], v132 offset:32640
    s_mov_b64 exec, -1
    s_waitcnt lgkmcnt(2)
    v_mfma_f32_32x32x16_bf16 v[152:167], v[116:119], v[112:115], v[152:167]
    ds_read_b128 v[116:119], v104 offset:33280
    s_nop 7
    s_waitcnt vmcnt(11)
    v_smfmac_f32_32x32x32_bf16 v[136:151], v[128:131], v[176:183], v133
    s_setprio 0
    v_exp_f32 v152, v152
    v_exp_f32 v153, v153
    v_exp_f32 v154, v154
    v_exp_f32 v155, v155
    v_exp_f32 v156, v156
    v_exp_f32 v157, v157
    v_exp_f32 v158, v158
    v_exp_f32 v159, v159
    v_exp_f32 v160, v160
    v_exp_f32 v161, v161
    s_setprio 1
    v_exp_f32 v162, v162
    v_exp_f32 v163, v163
    s_setprio 3
    v_mfma_f32_16x16x32_bf16 v[68:71], v[212:215], v[192:195], v[68:71]
    v_exp_f32 v164, v164
    v_mfma_f32_16x16x32_bf16 v[72:75], v[216:219], v[192:195], v[72:75]
    v_exp_f32 v165, v165
    v_mfma_f32_16x16x32_bf16 v[76:79], v[200:203], v[196:199], v[76:79]
    v_exp_f32 v166, v166
    v_mfma_f32_16x16x32_bf16 v[80:83], v[204:207], v[196:199], v[80:83]
    v_exp_f32 v167, v167
    s_setprio 2
    v_mfma_f32_32x32x8_bf16 v[168:183], v[110:111], v[108:109], 0
    ds_read_b64 v[110:111], v105 offset:36864
    s_add_u32 s13, s88, 40960
    buffer_load_dwordx4 v[200:203], v96, s[52:55], s13 offen sc1
    s_waitcnt lgkmcnt(3)
    v_smfmac_f32_32x32x32_bf16 v[136:151], v[120:123], v[152:159], v133
    s_mov_b64 exec, s[86:87]
    ds_read_b128 v[120:123], v132 offset:34560
    ds_read_b128 v[128:131], v132 offset:35200
    s_mov_b64 exec, -1
    s_waitcnt lgkmcnt(3)
    v_mfma_f32_32x32x16_bf16 v[168:183], v[116:119], v[112:115], v[168:183]
    ds_read_b128 v[116:119], v104 offset:35840
    s_add_u32 s13, s88, 41984
    buffer_load_dwordx4 v[204:207], v96, s[52:55], s13 offen sc1
    s_nop 6
    v_smfmac_f32_32x32x32_bf16 v[136:151], v[124:127], v[160:167], v133
    s_setprio 0
    v_exp_f32 v168, v168
    v_exp_f32 v169, v169
    v_exp_f32 v170, v170
    v_exp_f32 v171, v171
    v_exp_f32 v172, v172
    v_exp_f32 v173, v173
    v_exp_f32 v174, v174
    v_exp_f32 v175, v175
    v_exp_f32 v176, v176
    v_exp_f32 v177, v177
    s_setprio 1
    v_exp_f32 v178, v178
    v_exp_f32 v179, v179
    v_exp_f32 v180, v180
    s_setprio 3
    v_mfma_f32_16x16x32_bf16 v[84:87], v[208:211], v[196:199], v[84:87]
    v_exp_f32 v181, v181
    v_mfma_f32_16x16x32_bf16 v[88:91], v[212:215], v[196:199], v[88:91]
    v_exp_f32 v182, v182
    v_mfma_f32_16x16x32_bf16 v[92:95], v[216:219], v[196:199], v[92:95]
    v_exp_f32 v183, v183
    s_setprio 2
    s_waitcnt lgkmcnt(3)
    v_mfma_f32_32x32x8_bf16 v[152:167], v[110:111], v[106:107], 0
    s_add_u32 s13, s88, 43008
    buffer_load_dwordx4 v[208:211], v96, s[52:55], s13 offen sc1
    s_waitcnt lgkmcnt(2)
    v_smfmac_f32_32x32x32_bf16 v[136:151], v[120:123], v[168:175], v133
    s_mov_b64 exec, s[86:87]
    ds_read_b128 v[120:123], v132 offset:37120
    ds_read_b128 v[124:127], v132 offset:37760
    s_mov_b64 exec, -1
    s_waitcnt lgkmcnt(2)
    v_mfma_f32_32x32x16_bf16 v[152:167], v[116:119], v[112:115], v[152:167]
    ds_read_b128 v[116:119], v104 offset:38400
    s_add_u32 s13, s88, 44032
    buffer_load_dwordx4 v[212:215], v96, s[52:55], s13 offen sc1
    s_nop 6
    v_smfmac_f32_32x32x32_bf16 v[136:151], v[128:131], v[176:183], v133
    s_setprio 0
    v_exp_f32 v152, v152
    v_exp_f32 v153, v153
    v_exp_f32 v154, v154
    v_exp_f32 v155, v155
    v_exp_f32 v156, v156
    v_exp_f32 v157, v157
    v_exp_f32 v158, v158
    v_exp_f32 v159, v159
    s_setprio 1
    v_exp_f32 v160, v160
    v_exp_f32 v161, v161
    v_exp_f32 v162, v162
    v_exp_f32 v163, v163
    v_exp_f32 v164, v164
    v_exp_f32 v165, v165
    v_exp_f32 v166, v166
    v_exp_f32 v167, v167
    s_setprio 2
    v_mfma_f32_32x32x8_bf16 v[168:183], v[110:111], v[108:109], 0
    s_add_u32 s13, s88, 45056
    buffer_load_dwordx4 v[216:219], v96, s[52:55], s13 offen sc1
    s_waitcnt lgkmcnt(2)
    v_smfmac_f32_32x32x32_bf16 v[136:151], v[120:123], v[152:159], v133
    s_mov_b64 exec, s[86:87]
    ds_read_b128 v[120:123], v132 offset:39680
    ds_read_b128 v[128:131], v132 offset:40320
    s_mov_b64 exec, -1
    s_waitcnt lgkmcnt(2)
    v_mfma_f32_32x32x16_bf16 v[168:183], v[116:119], v[112:115], v[168:183]
    s_nop 9
    v_smfmac_f32_32x32x32_bf16 v[136:151], v[124:127], v[160:167], v133
    s_setprio 0
    v_exp_f32 v168, v168
    v_exp_f32 v169, v169
    v_exp_f32 v170, v170
    v_exp_f32 v171, v171
    v_exp_f32 v172, v172
    v_exp_f32 v173, v173
    v_exp_f32 v174, v174
    v_exp_f32 v175, v175
    s_setprio 1
    v_exp_f32 v176, v176
    v_exp_f32 v177, v177
    v_exp_f32 v178, v178
    v_exp_f32 v179, v179
    v_exp_f32 v180, v180
    v_exp_f32 v181, v181
    v_exp_f32 v182, v182
    v_exp_f32 v183, v183
    s_setprio 2
    s_nop 0
    s_waitcnt lgkmcnt(1)
    v_smfmac_f32_32x32x32_bf16 v[136:151], v[120:123], v[168:175], v133
    s_waitcnt lgkmcnt(0)
    v_smfmac_f32_32x32x32_bf16 v[136:151], v[128:131], v[176:183], v133
    s_waitcnt vmcnt(10)
    v_sub_f32 v8, 1.0, v8
    v_sub_f32 v9, 1.0, v9
    v_sub_f32 v10, 1.0, v10
    v_sub_f32 v11, 1.0, v11
    v_sub_f32 v102, 1.0, v102
    v_sub_f32 v103, 1.0, v103
    s_nop 5
    v_pk_fma_f32 v[100:101], v[136:137], 0, v[148:149]
    v_pk_fma_f32 v[100:101], v[138:139], 0, v[100:101]
    v_pk_fma_f32 v[100:101], v[140:141], 0, v[100:101]
    v_pk_fma_f32 v[100:101], v[142:143], 0, v[100:101]
    v_pk_fma_f32 v[100:101], v[144:145], 0, v[100:101]
    v_pk_fma_f32 v[100:101], v[146:147], 0, v[100:101]
    v_add_f32 v100, v100, v101
    v_cmp_nle_f32 vcc, 0x26800000, v100
    s_mov_b64 s[96:97], vcc
    v_cmp_nge_f32 vcc, 0x71800000, v100
    s_or_b64 vcc, vcc, s[96:97]
    s_cbranch_scc1 L_fb
L_fb_back:
    v_rcp_f32 v100, v148
    s_nop 0
    v_mul_f32 v100, v100, v134
    v_pk_mul_f32 v[136:137], v[136:137], v[100:101] op_sel_hi:[1,0]
    v_pk_mul_f32 v[138:139], v[138:139], v[100:101] op_sel_hi:[1,0]
    v_pk_mul_f32 v[140:141], v[140:141], v[100:101] op_sel_hi:[1,0]
    v_pk_mul_f32 v[142:143], v[142:143], v[100:101] op_sel_hi:[1,0]
    v_pk_mul_f32 v[144:145], v[144:145], v[100:101] op_sel_hi:[1,0]
    v_pk_mul_f32 v[146:147], v[146:147], v[100:101] op_sel_hi:[1,0]
    v_and_b32 v136, 0xfffe0000, v136
    v_and_b32 v140, 0xfffe0000, v140
    v_and_b32 v144, 0xfffe0000, v144
    v_cvt_pk_bf16_f32 v136, v136, v137
    v_cvt_pk_bf16_f32 v137, v138, v139
    v_cvt_pk_bf16_f32 v138, v140, v141
    v_cvt_pk_bf16_f32 v139, v142, v143
    v_cvt_pk_bf16_f32 v140, v144, v145
    v_cvt_pk_bf16_f32 v141, v146, v147
    v_or_b32 v136, 1, v136
    v_or_b32 v138, 1, v138
    v_or_b32 v140, 1, v140
    buffer_store_dwordx4 v[136:139], v96, s[52:55], s90 offen sc1
    s_mov_b32 exec_hi, 0
    buffer_store_dwordx2 v[140:141], v97, s[52:55], s90 offen offset:1024 sc1
    s_mov_b64 exec, -1
    s_setprio 0
    s_barrier
    v_lshrrev_b32 v106, 4, v0
    v_and_b32 v107, 15, v0
    v_lshrrev_b32 v108, 1, v106
    v_mul_u32_u24 v108, 81920, v108
    v_and_b32 v110, 1, v106
    v_lshl_add_u32 v108, v110, 9, v108
    v_lshl_add_u32 v108, v107, 4, v108
    v_mul_u32_u24 v110, 163840, v106
    v_lshl_add_u32 v110, v107, 4, v110
    s_mul_i32 s12, s8, 655360
    s_add_u32 s12, s12, 65536
    s_mul_i32 s13, s84, 1280
    s_add_u32 s101, s12, s13
    s_mul_i32 s14, s9, 327680
    s_add_u32 s89, s101, s14
    s_xor_b32 s13, s84, 1
    s_mulk_i32 s13, 1280
    s_add_u32 s12, s12, s14
    s_add_u32 s95, s12, s13
    v_add_u32 v109, 163840, v108
    v_add_u32 v111, 81920, v110
    s_mov_b32 s100, 400000
    v_mul_u32_u24 v126, 1280, v107
    v_add_u32 v135, v126, v135
    v_add_u32 v126, v126, v1
    s_lshr_b32 s15, s3, 1
    s_lshl_b32 s12, s15, 8
    s_and_b32 s11, s3, 1
    s_lshl_b32 s13, s11, 3
    v_bitop3_b32 v127, v107, s13, 8 bitop3:0x28
    s_mul_i32 s13, s9, 40960
    s_add_u32 s14, s12, s13
    s_sub_u32 s12, s12, s13
    s_add_u32 s12, s12, 40960
    v_lshl_add_u32 v127, v106, 10, v127
    v_lshl_add_u32 v127, v107, 4, v127
    v_add_u32 v112, s14, v127
    v_add_u32 v113, s12, v127
    s_mulk_i32 s15, 20480
    s_lshl_b32 s11, s11, 13
    s_add_u32 s15, s15, s11
    v_add_u32 v124, s15, v96
    s_mul_i32 s15, s8, 20480
    v_add_u32 v125, s15, v96
    v_pk_mul_f32 v[16:17], v[16:17], v[8:9] op_sel:[0,0] op_sel_hi:[1,0]
    v_pk_mul_f32 v[18:19], v[18:19], v[8:9] op_sel:[0,0] op_sel_hi:[1,0]
    v_pk_mul_f32 v[20:21], v[20:21], v[8:9] op_sel:[0,0] op_sel_hi:[1,0]
    v_pk_mul_f32 v[22:23], v[22:23], v[8:9] op_sel:[0,0] op_sel_hi:[1,0]
    v_pk_mul_f32 v[24:25], v[24:25], v[8:9] op_sel:[0,0] op_sel_hi:[1,0]
    v_pk_mul_f32 v[26:27], v[26:27], v[8:9] op_sel:[0,0] op_sel_hi:[1,0]
    v_pk_mul_f32 v[28:29], v[28:29], v[8:9] op_sel:[0,0] op_sel_hi:[1,0]
    v_pk_mul_f32 v[30:31], v[30:31], v[8:9] op_sel:[0,0] op_sel_hi:[1,0]
    v_pk_mul_f32 v[32:33], v[32:33], v[8:9] op_sel:[0,0] op_sel_hi:[1,0]
    v_pk_mul_f32 v[34:35], v[34:35], v[8:9] op_sel:[0,0] op_sel_hi:[1,0]
    v_pk_mul_f32 v[36:37], v[36:37], v[8:9] op_sel:[0,1] op_sel_hi:[1,1]
    v_pk_mul_f32 v[38:39], v[38:39], v[8:9] op_sel:[0,1] op_sel_hi:[1,1]
    v_pk_mul_f32 v[40:41], v[40:41], v[8:9] op_sel:[0,1] op_sel_hi:[1,1]
    v_pk_mul_f32 v[42:43], v[42:43], v[8:9] op_sel:[0,1] op_sel_hi:[1,1]
    v_pk_mul_f32 v[44:45], v[44:45], v[8:9] op_sel:[0,1] op_sel_hi:[1,1]
    v_pk_mul_f32 v[46:47], v[46:47], v[8:9] op_sel:[0,1] op_sel_hi:[1,1]
    v_pk_mul_f32 v[48:49], v[48:49], v[8:9] op_sel:[0,1] op_sel_hi:[1,1]
    v_pk_mul_f32 v[50:51], v[50:51], v[8:9] op_sel:[0,1] op_sel_hi:[1,1]
    v_pk_mul_f32 v[52:53], v[52:53], v[8:9] op_sel:[0,1] op_sel_hi:[1,1]
    v_pk_mul_f32 v[54:55], v[54:55], v[8:9] op_sel:[0,1] op_sel_hi:[1,1]
    v_pk_mul_f32 v[56:57], v[56:57], v[10:11] op_sel:[0,0] op_sel_hi:[1,0]
    v_pk_mul_f32 v[58:59], v[58:59], v[10:11] op_sel:[0,0] op_sel_hi:[1,0]
    v_pk_mul_f32 v[60:61], v[60:61], v[10:11] op_sel:[0,0] op_sel_hi:[1,0]
    v_pk_mul_f32 v[62:63], v[62:63], v[10:11] op_sel:[0,0] op_sel_hi:[1,0]
    v_pk_mul_f32 v[64:65], v[64:65], v[10:11] op_sel:[0,0] op_sel_hi:[1,0]
    v_pk_mul_f32 v[66:67], v[66:67], v[10:11] op_sel:[0,0] op_sel_hi:[1,0]
    v_pk_mul_f32 v[68:69], v[68:69], v[10:11] op_sel:[0,0] op_sel_hi:[1,0]
    v_pk_mul_f32 v[70:71], v[70:71], v[10:11] op_sel:[0,0] op_sel_hi:[1,0]
    v_pk_mul_f32 v[72:73], v[72:73], v[10:11] op_sel:[0,0] op_sel_hi:[1,0]
    v_pk_mul_f32 v[74:75], v[74:75], v[10:11] op_sel:[0,0] op_sel_hi:[1,0]
    v_pk_mul_f32 v[76:77], v[76:77], v[10:11] op_sel:[0,1] op_sel_hi:[1,1]
    v_pk_mul_f32 v[78:79], v[78:79], v[10:11] op_sel:[0,1] op_sel_hi:[1,1]
    v_pk_mul_f32 v[80:81], v[80:81], v[10:11] op_sel:[0,1] op_sel_hi:[1,1]
    v_pk_mul_f32 v[82:83], v[82:83], v[10:11] op_sel:[0,1] op_sel_hi:[1,1]
    v_pk_mul_f32 v[84:85], v[84:85], v[10:11] op_sel:[0,1] op_sel_hi:[1,1]
    v_pk_mul_f32 v[86:87], v[86:87], v[10:11] op_sel:[0,1] op_sel_hi:[1,1]
    v_pk_mul_f32 v[88:89], v[88:89], v[10:11] op_sel:[0,1] op_sel_hi:[1,1]
    v_pk_mul_f32 v[90:91], v[90:91], v[10:11] op_sel:[0,1] op_sel_hi:[1,1]
    v_pk_mul_f32 v[92:93], v[92:93], v[10:11] op_sel:[0,1] op_sel_hi:[1,1]
    v_pk_mul_f32 v[94:95], v[94:95], v[10:11] op_sel:[0,1] op_sel_hi:[1,1]
    v_lshlrev_b32 v140, 16, v2
    v_and_b32 v141, 0xffff0000, v2
    v_lshlrev_b32 v142, 16, v3
    v_and_b32 v143, 0xffff0000, v3
    v_mul_f32 v140, v140, v102
    v_mul_f32 v141, v141, v102
    v_mul_f32 v142, v142, v102
    v_mul_f32 v143, v143, v102
    v_lshlrev_b32 v144, 16, v4
    v_and_b32 v145, 0xffff0000, v4
    v_lshlrev_b32 v146, 16, v5
    v_and_b32 v147, 0xffff0000, v5
    v_mul_f32 v144, v144, v102
    v_mul_f32 v145, v145, v102
    v_mul_f32 v146, v146, v102
    v_mul_f32 v147, v147, v102
    v_lshlrev_b32 v148, 16, v6
    v_and_b32 v149, 0xffff0000, v6
    v_lshlrev_b32 v150, 16, v7
    v_and_b32 v151, 0xffff0000, v7
    v_mul_f32 v148, v148, v103
    v_mul_f32 v149, v149, v103
    v_mul_f32 v150, v150, v103
    v_mul_f32 v151, v151, v103
    s_waitcnt vmcnt(0)
    buffer_load_dwordx4 v[160:163], v108, s[52:55], s95 offen offset:0 sc1
    buffer_load_dwordx4 v[176:179], v109, s[52:55], s95 offen offset:0 sc1
    buffer_load_dwordx4 v[164:167], v108, s[52:55], s95 offen offset:256 sc1
    buffer_load_dwordx4 v[180:183], v109, s[52:55], s95 offen offset:256 sc1
    v_mov_b32 v138, 0x3f80
    v_and_b32 v136, 1, v0
    v_lshlrev_b32 v136, 4, v136
    v_lshlrev_b32 v136, v136, v138
    v_bfe_i32 v137, v0, 1, 1
    v_and_b32 v137, v137, v136
    v_xor_b32 v136, v136, v137
    v_mov_b64 v[184:185], 0
    v_mov_b64 v[186:187], 0
    v_mov_b64 v[188:189], 0
    v_mov_b64 v[190:191], 0
    v_mov_b64 v[192:193], 0
    v_mov_b64 v[194:195], 0
    v_mov_b64 v[196:197], 0
    v_mov_b64 v[198:199], 0
    s_mov_b32 exec_lo, 0xf000f
    s_mov_b32 exec_hi, 0xf000f
    v_mov_b64 v[184:185], v[136:137]
    v_mov_b64 v[186:187], v[136:137]
    s_mov_b32 exec_lo, 0xf000f0
    s_mov_b32 exec_hi, 0xf000f0
    v_mov_b64 v[188:189], v[136:137]
    v_mov_b64 v[190:191], v[136:137]
    s_mov_b32 exec_lo, 0xf000f00
    s_mov_b32 exec_hi, 0xf000f00
    v_mov_b64 v[192:193], v[136:137]
    v_mov_b64 v[194:195], v[136:137]
    s_mov_b32 exec_lo, 0xf000f000
    s_mov_b32 exec_hi, 0xf000f000
    v_mov_b64 v[196:197], v[136:137]
    v_mov_b64 v[198:199], v[136:137]
    s_mov_b64 exec, -1
    buffer_load_dwordx4 v[152:155], v108, s[52:55], s89 offen offset:0 sc1
    buffer_load_dwordx4 v[168:171], v109, s[52:55], s89 offen offset:0 sc1
    buffer_load_dwordx4 v[116:119], v110, s[52:55], s101 offen offset:1024 sc1
    buffer_load_dwordx4 v[120:123], v111, s[52:55], s101 offen offset:1024 sc1
    buffer_load_dwordx4 v[156:159], v108, s[52:55], s89 offen offset:256 sc1
    buffer_load_dwordx4 v[172:175], v109, s[52:55], s89 offen offset:256 sc1
    s_setprio 3
    s_waitcnt vmcnt(8)
    v_bitop3_b32 v127, 1, v160, v162 bitop3:0x80
    v_bitop3_b32 v127, v127, v176, v178 bitop3:0x80
    v_cmp_eq_u32 vcc, 0, v127
    s_cbranch_vccnz L_ort2
L_ook2:
    v_mfma_f32_16x16x32_bf16 v[56:59], v[236:239], v[160:163], v[56:59]
    v_mfma_f32_16x16x32_bf16 v[60:63], v[240:243], v[160:163], v[60:63]
    v_mfma_f32_16x16x32_bf16 v[64:67], v[244:247], v[160:163], v[64:67]
    v_mfma_f32_16x16x32_bf16 v[68:71], v[248:251], v[160:163], v[68:71]
    v_mfma_f32_16x16x32_bf16 v[72:75], v[252:255], v[160:163], v[72:75]
    v_mfma_f32_16x16x32_bf16 v[56:59], v[200:203], v[176:179], v[56:59]
    v_mfma_f32_16x16x32_bf16 v[60:63], v[204:207], v[176:179], v[60:63]
    v_mfma_f32_16x16x32_bf16 v[64:67], v[208:211], v[176:179], v[64:67]
    v_mfma_f32_16x16x32_bf16 v[68:71], v[212:215], v[176:179], v[68:71]
    v_mfma_f32_16x16x32_bf16 v[72:75], v[216:219], v[176:179], v[72:75]
    s_setprio 2
    s_waitcnt vmcnt(6)
    v_bitop3_b32 v127, 1, v164, v166 bitop3:0x80
    v_bitop3_b32 v127, v127, v180, v182 bitop3:0x80
    v_cmp_eq_u32 vcc, 0, v127
    s_cbranch_vccnz L_ort3
L_ook3:
    v_mfma_f32_16x16x32_bf16 v[76:79], v[236:239], v[164:167], v[76:79]
    v_cvt_pk_bf16_f32 v56, v56, v57
    v_cvt_pk_bf16_f32 v57, v58, v59
    v_mfma_f32_16x16x32_bf16 v[80:83], v[240:243], v[164:167], v[80:83]
    ds_write_b64 v113, v[56:57] offset:0
    v_mfma_f32_16x16x32_bf16 v[84:87], v[244:247], v[164:167], v[84:87]
    v_cvt_pk_bf16_f32 v60, v60, v61
    v_cvt_pk_bf16_f32 v61, v62, v63
    v_mfma_f32_16x16x32_bf16 v[88:91], v[248:251], v[164:167], v[88:91]
    ds_write_b64 v113, v[60:61] offset:4096
    v_mfma_f32_16x16x32_bf16 v[92:95], v[252:255], v[164:167], v[92:95]
    v_cvt_pk_bf16_f32 v64, v64, v65
    v_cvt_pk_bf16_f32 v65, v66, v67
    v_mfma_f32_16x16x32_bf16 v[76:79], v[200:203], v[180:183], v[76:79]
    ds_write_b64 v113, v[64:65] offset:8192
    v_mfma_f32_16x16x32_bf16 v[80:83], v[204:207], v[180:183], v[80:83]
    v_cvt_pk_bf16_f32 v68, v68, v69
    v_cvt_pk_bf16_f32 v69, v70, v71
    v_mfma_f32_16x16x32_bf16 v[84:87], v[208:211], v[180:183], v[84:87]
    ds_write_b64 v113, v[68:69] offset:12288
    v_mfma_f32_16x16x32_bf16 v[88:91], v[212:215], v[180:183], v[88:91]
    v_cvt_pk_bf16_f32 v72, v72, v73
    v_cvt_pk_bf16_f32 v73, v74, v75
    v_mfma_f32_16x16x32_bf16 v[92:95], v[216:219], v[180:183], v[92:95]
    ds_write_b64 v113, v[72:73] offset:16384
    s_setprio 1
    s_waitcnt vmcnt(2)
    v_bitop3_b32 v127, 1, v152, v154 bitop3:0x80
    v_bitop3_b32 v127, v127, v168, v170 bitop3:0x80
    v_bitop3_b32 v127, v127, v116, v118 bitop3:0x80
    v_bitop3_b32 v127, v127, v120, v122 bitop3:0x80
    v_cmp_eq_u32 vcc, 0, v127
    s_cbranch_vccnz L_ort0
L_ook0:
    v_swap_b32 v118, v120
    v_swap_b32 v119, v121
    v_mfma_f32_16x16x32_bf16 v[16:19], v[236:239], v[152:155], v[16:19]
    v_cvt_pk_bf16_f32 v76, v76, v77
    v_cvt_pk_bf16_f32 v77, v78, v79
    v_mfma_f32_16x16x32_bf16 v[20:23], v[240:243], v[152:155], v[20:23]
    ds_write_b64 v113, v[76:77] offset:20480
    v_mfma_f32_16x16x32_bf16 v[24:27], v[244:247], v[152:155], v[24:27]
    v_cvt_pk_bf16_f32 v80, v80, v81
    v_cvt_pk_bf16_f32 v81, v82, v83
    v_mfma_f32_16x16x32_bf16 v[28:31], v[248:251], v[152:155], v[28:31]
    ds_write_b64 v113, v[80:81] offset:24576
    v_mfma_f32_16x16x32_bf16 v[32:35], v[252:255], v[152:155], v[32:35]
    v_cvt_pk_bf16_f32 v84, v84, v85
    v_cvt_pk_bf16_f32 v85, v86, v87
    v_mfma_f32_16x16x32_bf16 v[16:19], v[200:203], v[168:171], v[16:19]
    ds_write_b64 v113, v[84:85] offset:28672
    v_mfma_f32_16x16x32_bf16 v[20:23], v[204:207], v[168:171], v[20:23]
    v_cvt_pk_bf16_f32 v88, v88, v89
    v_cvt_pk_bf16_f32 v89, v90, v91
    v_mfma_f32_16x16x32_bf16 v[24:27], v[208:211], v[168:171], v[24:27]
    ds_write_b64 v113, v[88:89] offset:32768
    v_mfma_f32_16x16x32_bf16 v[28:31], v[212:215], v[168:171], v[28:31]
    v_cvt_pk_bf16_f32 v92, v92, v93
    v_cvt_pk_bf16_f32 v93, v94, v95
    v_mfma_f32_16x16x32_bf16 v[32:35], v[216:219], v[168:171], v[32:35]
    ds_write_b64 v113, v[92:93] offset:36864
    v_mfma_f32_16x16x32_bf16 v[16:19], v[220:223], v[116:119], v[16:19]
    v_mfma_f32_16x16x32_bf16 v[20:23], v[224:227], v[116:119], v[20:23]
    v_mfma_f32_16x16x32_bf16 v[24:27], v[228:231], v[116:119], v[24:27]
    v_mfma_f32_16x16x32_bf16 v[28:31], v[232:235], v[116:119], v[28:31]
    v_mfma_f32_16x16x32_bf16 v[32:35], v[12:15], v[116:119], v[32:35]
    s_setprio 0
    s_waitcnt vmcnt(0)
    v_bitop3_b32 v127, 1, v156, v158 bitop3:0x80
    v_bitop3_b32 v127, v127, v172, v174 bitop3:0x80
    v_cmp_eq_u32 vcc, 0, v127
    s_cbranch_vccnz L_ort1
L_ook1:
    v_mfma_f32_16x16x32_bf16 v[36:39], v[236:239], v[156:159], v[36:39]
    v_cvt_pk_bf16_f32 v16, v16, v17
    v_cvt_pk_bf16_f32 v17, v18, v19
    v_mfma_f32_16x16x32_bf16 v[40:43], v[240:243], v[156:159], v[40:43]
    ds_write_b64 v112, v[16:17] offset:0
    v_mfma_f32_16x16x32_bf16 v[44:47], v[244:247], v[156:159], v[44:47]
    v_cvt_pk_bf16_f32 v20, v20, v21
    v_cvt_pk_bf16_f32 v21, v22, v23
    v_mfma_f32_16x16x32_bf16 v[48:51], v[248:251], v[156:159], v[48:51]
    ds_write_b64 v112, v[20:21] offset:4096
    v_mfma_f32_16x16x32_bf16 v[52:55], v[252:255], v[156:159], v[52:55]
    v_cvt_pk_bf16_f32 v24, v24, v25
    v_cvt_pk_bf16_f32 v25, v26, v27
    v_mfma_f32_16x16x32_bf16 v[36:39], v[200:203], v[172:175], v[36:39]
    ds_write_b64 v112, v[24:25] offset:8192
    v_mfma_f32_16x16x32_bf16 v[40:43], v[204:207], v[172:175], v[40:43]
    v_cvt_pk_bf16_f32 v28, v28, v29
    v_cvt_pk_bf16_f32 v29, v30, v31
    v_mfma_f32_16x16x32_bf16 v[44:47], v[208:211], v[172:175], v[44:47]
    ds_write_b64 v112, v[28:29] offset:12288
    v_mfma_f32_16x16x32_bf16 v[48:51], v[212:215], v[172:175], v[48:51]
    v_cvt_pk_bf16_f32 v32, v32, v33
    v_cvt_pk_bf16_f32 v33, v34, v35
    v_mfma_f32_16x16x32_bf16 v[52:55], v[216:219], v[172:175], v[52:55]
    ds_write_b64 v112, v[32:33] offset:16384
    v_mfma_f32_16x16x32_bf16 v[36:39], v[220:223], v[120:123], v[36:39]
    v_mfma_f32_16x16x32_bf16 v[40:43], v[224:227], v[120:123], v[40:43]
    v_mfma_f32_16x16x32_bf16 v[44:47], v[228:231], v[120:123], v[44:47]
    v_mfma_f32_16x16x32_bf16 v[48:51], v[232:235], v[120:123], v[48:51]
    v_mfma_f32_16x16x32_bf16 v[52:55], v[12:15], v[120:123], v[52:55]
    s_nop 3
    v_cvt_pk_bf16_f32 v36, v36, v37
    v_cvt_pk_bf16_f32 v37, v38, v39
    v_cvt_pk_bf16_f32 v40, v40, v41
    v_cvt_pk_bf16_f32 v41, v42, v43
    ds_write_b64 v112, v[36:37] offset:20480
    v_cvt_pk_bf16_f32 v44, v44, v45
    v_cvt_pk_bf16_f32 v45, v46, v47
    ds_write_b64 v112, v[40:41] offset:24576
    v_cvt_pk_bf16_f32 v48, v48, v49
    v_cvt_pk_bf16_f32 v49, v50, v51
    ds_write_b64 v112, v[44:45] offset:28672
    v_cvt_pk_bf16_f32 v52, v52, v53
    v_cvt_pk_bf16_f32 v53, v54, v55
    ds_write_b64 v112, v[48:49] offset:32768
    ds_write_b64 v112, v[52:53] offset:36864
    s_waitcnt lgkmcnt(0)
    s_barrier
    ds_read_b128 v[16:19], v124 offset:0
    ds_read_b128 v[24:27], v124 offset:2048
    ds_read_b128 v[32:35], v124 offset:4096
    ds_read_b128 v[40:43], v124 offset:6144
    ds_read_b128 v[20:23], v124 offset:1024
    ds_read_b128 v[28:31], v124 offset:3072
    ds_read_b128 v[36:39], v124 offset:5120
    ds_read_b128 v[44:47], v124 offset:7168
    s_cmp_ge_u32 s3, 4
    s_cbranch_scc1 L_two
    ds_read_b128 v[48:51], v125 offset:16384
    ds_read_b128 v[52:55], v125 offset:17408
    ds_read_b128 v[56:59], v125 offset:18432
    ds_read_b128 v[60:63], v125 offset:19456
    s_waitcnt lgkmcnt(11)
    v_mfma_f32_16x16x32_bf16 v[140:143], v[184:187], v[16:19], v[140:143]
    s_waitcnt lgkmcnt(10)
    v_mfma_f32_16x16x32_bf16 v[140:143], v[188:191], v[24:27], v[140:143]
    s_waitcnt lgkmcnt(9)
    v_mfma_f32_16x16x32_bf16 v[140:143], v[192:195], v[32:35], v[140:143]
    s_waitcnt lgkmcnt(8)
    v_mfma_f32_16x16x32_bf16 v[140:143], v[196:199], v[40:43], v[140:143]
    s_waitcnt lgkmcnt(7)
    v_mfma_f32_16x16x32_bf16 v[144:147], v[184:187], v[20:23], v[144:147]
    s_waitcnt lgkmcnt(6)
    v_mfma_f32_16x16x32_bf16 v[144:147], v[188:191], v[28:31], v[144:147]
    s_waitcnt lgkmcnt(5)
    v_mfma_f32_16x16x32_bf16 v[144:147], v[192:195], v[36:39], v[144:147]
    s_waitcnt lgkmcnt(4)
    v_mfma_f32_16x16x32_bf16 v[144:147], v[196:199], v[44:47], v[144:147]
    s_waitcnt lgkmcnt(3)
    v_mfma_f32_16x16x32_bf16 v[148:151], v[184:187], v[48:51], v[148:151]
    s_waitcnt lgkmcnt(2)
    v_mfma_f32_16x16x32_bf16 v[148:151], v[188:191], v[52:55], v[148:151]
    s_waitcnt lgkmcnt(1)
    v_mfma_f32_16x16x32_bf16 v[148:151], v[192:195], v[56:59], v[148:151]
    s_waitcnt lgkmcnt(0)
    v_mfma_f32_16x16x32_bf16 v[148:151], v[196:199], v[60:63], v[148:151]
    v_cvt_pk_bf16_f32 v140, v140, v141
    v_cvt_pk_bf16_f32 v141, v142, v143
    v_cvt_pk_bf16_f32 v142, v144, v145
    v_cvt_pk_bf16_f32 v143, v146, v147
    buffer_store_dwordx4 v[140:143], v126, s[72:75], s98 offen
    s_nop 2
    v_cvt_pk_bf16_f32 v148, v148, v149
    v_cvt_pk_bf16_f32 v149, v150, v151
    buffer_store_dwordx2 v[148:149], v135, s[72:75], s99 offen
    s_endpgm
L_two:
    s_waitcnt lgkmcnt(7)
    v_mfma_f32_16x16x32_bf16 v[140:143], v[184:187], v[16:19], v[140:143]
    s_waitcnt lgkmcnt(6)
    v_mfma_f32_16x16x32_bf16 v[140:143], v[188:191], v[24:27], v[140:143]
    s_waitcnt lgkmcnt(5)
    v_mfma_f32_16x16x32_bf16 v[140:143], v[192:195], v[32:35], v[140:143]
    s_waitcnt lgkmcnt(4)
    v_mfma_f32_16x16x32_bf16 v[140:143], v[196:199], v[40:43], v[140:143]
    s_waitcnt lgkmcnt(3)
    v_mfma_f32_16x16x32_bf16 v[144:147], v[184:187], v[20:23], v[144:147]
    s_waitcnt lgkmcnt(2)
    v_mfma_f32_16x16x32_bf16 v[144:147], v[188:191], v[28:31], v[144:147]
    s_waitcnt lgkmcnt(1)
    v_mfma_f32_16x16x32_bf16 v[144:147], v[192:195], v[36:39], v[144:147]
    s_waitcnt lgkmcnt(0)
    v_mfma_f32_16x16x32_bf16 v[144:147], v[196:199], v[44:47], v[144:147]
    s_nop 5
    v_cvt_pk_bf16_f32 v140, v140, v141
    v_cvt_pk_bf16_f32 v141, v142, v143
    v_cvt_pk_bf16_f32 v142, v144, v145
    v_cvt_pk_bf16_f32 v143, v146, v147
    buffer_store_dwordx4 v[140:143], v126, s[72:75], s98 offen
L_fin:
L_end:
    s_endpgm
L_ort2:
    buffer_load_dwordx4 v[160:163], v108, s[52:55], s95 offen offset:0 sc1
    buffer_load_dwordx4 v[176:179], v109, s[52:55], s95 offen offset:0 sc1
    buffer_load_dwordx4 v[164:167], v108, s[52:55], s95 offen offset:256 sc1
    buffer_load_dwordx4 v[180:183], v109, s[52:55], s95 offen offset:256 sc1
    buffer_load_dwordx4 v[152:155], v108, s[52:55], s89 offen offset:0 sc1
    buffer_load_dwordx4 v[168:171], v109, s[52:55], s89 offen offset:0 sc1
    buffer_load_dwordx4 v[116:119], v110, s[52:55], s101 offen offset:1024 sc1
    buffer_load_dwordx4 v[120:123], v111, s[52:55], s101 offen offset:1024 sc1
    buffer_load_dwordx4 v[156:159], v108, s[52:55], s89 offen offset:256 sc1
    buffer_load_dwordx4 v[172:175], v109, s[52:55], s89 offen offset:256 sc1
    s_waitcnt vmcnt(0)
    v_bitop3_b32 v127, 1, v160, v162 bitop3:0x80
    v_bitop3_b32 v127, v127, v176, v178 bitop3:0x80
    v_cmp_eq_u32 vcc, 0, v127
    s_sub_u32 s100, s100, 1
    s_cmp_lt_i32 s100, 1
    s_cbranch_scc1 L_ook2
    s_cbranch_vccnz L_ort2
    s_branch L_ook2
L_ort3:
    buffer_load_dwordx4 v[164:167], v108, s[52:55], s95 offen offset:256 sc1
    buffer_load_dwordx4 v[180:183], v109, s[52:55], s95 offen offset:256 sc1
    buffer_load_dwordx4 v[152:155], v108, s[52:55], s89 offen offset:0 sc1
    buffer_load_dwordx4 v[168:171], v109, s[52:55], s89 offen offset:0 sc1
    buffer_load_dwordx4 v[116:119], v110, s[52:55], s101 offen offset:1024 sc1
    buffer_load_dwordx4 v[120:123], v111, s[52:55], s101 offen offset:1024 sc1
    buffer_load_dwordx4 v[156:159], v108, s[52:55], s89 offen offset:256 sc1
    buffer_load_dwordx4 v[172:175], v109, s[52:55], s89 offen offset:256 sc1
    s_waitcnt vmcnt(0)
    v_bitop3_b32 v127, 1, v164, v166 bitop3:0x80
    v_bitop3_b32 v127, v127, v180, v182 bitop3:0x80
    v_cmp_eq_u32 vcc, 0, v127
    s_sub_u32 s100, s100, 1
    s_cmp_lt_i32 s100, 1
    s_cbranch_scc1 L_ook3
    s_cbranch_vccnz L_ort3
    s_branch L_ook3
L_ort0:
    buffer_load_dwordx4 v[152:155], v108, s[52:55], s89 offen offset:0 sc1
    buffer_load_dwordx4 v[168:171], v109, s[52:55], s89 offen offset:0 sc1
    buffer_load_dwordx4 v[116:119], v110, s[52:55], s101 offen offset:1024 sc1
    buffer_load_dwordx4 v[120:123], v111, s[52:55], s101 offen offset:1024 sc1
    buffer_load_dwordx4 v[156:159], v108, s[52:55], s89 offen offset:256 sc1
    buffer_load_dwordx4 v[172:175], v109, s[52:55], s89 offen offset:256 sc1
    s_waitcnt vmcnt(0)
    v_bitop3_b32 v127, 1, v152, v154 bitop3:0x80
    v_bitop3_b32 v127, v127, v168, v170 bitop3:0x80
    v_bitop3_b32 v127, v127, v116, v118 bitop3:0x80
    v_bitop3_b32 v127, v127, v120, v122 bitop3:0x80
    v_cmp_eq_u32 vcc, 0, v127
    s_sub_u32 s100, s100, 1
    s_cmp_lt_i32 s100, 1
    s_cbranch_scc1 L_ook0
    s_cbranch_vccnz L_ort0
    s_branch L_ook0
L_ort1:
    buffer_load_dwordx4 v[156:159], v108, s[52:55], s89 offen offset:256 sc1
    buffer_load_dwordx4 v[172:175], v109, s[52:55], s89 offen offset:256 sc1
    s_waitcnt vmcnt(0)
    v_bitop3_b32 v127, 1, v156, v158 bitop3:0x80
    v_bitop3_b32 v127, v127, v172, v174 bitop3:0x80
    v_cmp_eq_u32 vcc, 0, v127
    s_sub_u32 s100, s100, 1
    s_cmp_lt_i32 s100, 1
    s_cbranch_scc1 L_ook1
    s_cbranch_vccnz L_ort1
    s_branch L_ook1
L_fl_1:
    s_mov_b32 s100, 400000
L_fl_1_a:
    v_cmp_eq_u32 vcc, 0, v2
    s_cmp_eq_u64 vcc, 0
    s_cbranch_scc1 L_fl_1_b
    buffer_load_dword v2, v1, s[76:79], 0 offen sc1
    s_waitcnt vmcnt(0)
    s_sub_u32 s100, s100, 1
    s_cmp_lg_u32 s100, 0
    s_cbranch_scc1 L_fl_1_a
L_fl_1_b:
    s_lshl4_add_u32 s12, s7, s6
    s_lshl_b32 s12, s12, 7
    v_mov_b32 v1, 1
    s_mov_b64 exec, 1
    buffer_store_dword v1, off, s[52:55], s12 sc1
    s_mov_b64 exec, -1
    s_branch L_flr_2
L_plp_4:
    s_mov_b32 s100, 400000
L_plp_4_a:
    s_mov_b64 exec, 0xfff
    buffer_load_dword v101, v100, s[52:55], 0 offen sc1
    s_mov_b64 exec, -1
    s_waitcnt vmcnt(0)
    v_cmp_gt_u32 vcc, 1, v101
    s_and_b32 s11, vcc_lo, 0xfff
    s_cbranch_scc0 L_pok_3
    s_sub_u32 s100, s100, 1
    s_cmp_lg_u32 s100, 0
    s_cbranch_scc1 L_plp_4_a
    s_branch L_pok_3
L_fl_5:
    s_mov_b32 s100, 400000
L_fl_5_a:
    v_cmp_eq_u32 vcc, 0, v2
    s_cmp_eq_u64 vcc, 0
    s_cbranch_scc1 L_fl_5_b
    buffer_load_dword v2, v1, s[76:79], 0 offen sc1
    s_waitcnt vmcnt(0)
    s_sub_u32 s100, s100, 1
    s_cmp_lg_u32 s100, 0
    s_cbranch_scc1 L_fl_5_a
L_fl_5_b:
    s_lshl4_add_u32 s12, s7, s6
    s_lshl_b32 s12, s12, 7
    v_mov_b32 v1, 1
    s_mov_b64 exec, 1
    buffer_store_dword v1, off, s[52:55], s12 sc1
    s_mov_b64 exec, -1
    s_branch L_flr_6
L_plp_8:
    s_mov_b32 s100, 400000
L_plp_8_a:
    s_mov_b64 exec, 0xfff
    buffer_load_dword v101, v100, s[52:55], 0 offen sc1
    s_mov_b64 exec, -1
    s_waitcnt vmcnt(0)
    v_cmp_gt_u32 vcc, 1, v101
    s_and_b32 s11, vcc_lo, 0xfff
    s_cbranch_scc0 L_pok_7
    s_sub_u32 s100, s100, 1
    s_cmp_lg_u32 s100, 0
    s_cbranch_scc1 L_plp_8_a
    s_branch L_pok_7
L_fl_9:
    s_mov_b32 s100, 400000
L_fl_9_a:
    v_cmp_eq_u32 vcc, 0, v2
    s_cmp_eq_u64 vcc, 0
    s_cbranch_scc1 L_fl_9_b
    buffer_load_dword v2, v1, s[76:79], 0 offen sc1
    s_waitcnt vmcnt(0)
    s_sub_u32 s100, s100, 1
    s_cmp_lg_u32 s100, 0
    s_cbranch_scc1 L_fl_9_a
L_fl_9_b:
    s_lshl4_add_u32 s12, s7, s6
    s_lshl_b32 s12, s12, 7
    v_mov_b32 v1, 1
    s_mov_b64 exec, 1
    buffer_store_dword v1, off, s[52:55], s12 sc1
    s_mov_b64 exec, -1
    s_branch L_flr_10
L_plp_12:
    s_mov_b32 s100, 400000
L_plp_12_a:
    s_mov_b64 exec, 0xfff
    buffer_load_dword v101, v100, s[52:55], 0 offen sc1
    s_mov_b64 exec, -1
    s_waitcnt vmcnt(0)
    v_cmp_gt_u32 vcc, 1, v101
    s_and_b32 s11, vcc_lo, 0xfff
    s_cbranch_scc0 L_pok_11
    s_sub_u32 s100, s100, 1
    s_cmp_lg_u32 s100, 0
    s_cbranch_scc1 L_plp_12_a
    s_branch L_pok_11
L_plp_14:
    s_mov_b32 s100, 400000
L_plp_14_a:
    s_mov_b32 exec_hi, 0
    buffer_load_dword v101, v100, s[52:55], 0 offen sc1
    s_mov_b64 exec, -1
    s_waitcnt vmcnt(0)
    v_cmp_gt_u32 vcc, 2, v101
    s_and_b32 s11, vcc_lo, 0xffffffff
    s_cbranch_scc0 L_pok_13
    s_sub_u32 s100, s100, 1
    s_cmp_lg_u32 s100, 0
    s_cbranch_scc1 L_plp_14_a
    s_branch L_pok_13
L_p2g:
    s_add_u32 s11, s10, 98304
    s_mov_b32 m0, s11
    v_lshlrev_b32 v10, 4, v0
    v_and_b32 v15, 48, v0
    v_add_u32 v15, s11, v15
    buffer_load_dwordx4 v10, s[68:71], 0 offen offset:0 lds
    buffer_load_dwordx4 v10, s[68:71], 0 offen offset:1024 lds
    buffer_store_dwordx4 v[36:39], v12, s[52:55], s88 offen sc1
    buffer_store_dwordx4 v[40:43], v13, s[52:55], s88 offen sc1
    buffer_store_dwordx4 v[44:47], v14, s[52:55], s88 offen sc1
    s_lshl3_add_u32 s88, s6, s3
    s_lshl_b32 s91, s3, 12
    s_add_u32 s91, s91, 114688
    v_lshrrev_b32 v3, 5, v0
    v_bfe_u32 v6, v0, 3, 2
    v_and_b32 v5, 7, v0
    v_lshlrev_b32 v5, 4, v5
    v_bfe_u32 v4, v0, 2, 2
    v_lshlrev_b32 v4, 7, v4
    v_lshrrev_b32 v7, 4, v0
    v_lshl_add_u32 v4, v7, 10, v4
    v_and_b32 v7, 3, v0
    v_lshl_add_u32 v4, v7, 3, v4
    v_add_u32 v4, s91, v4
    s_cmp_lg_u32 s9, 0
    s_cbranch_scc1 L_nog
    s_waitcnt vmcnt(3) lgkmcnt(0)
    ds_read_b128 v[16:19], v15 offset:0
    ds_read_b128 v[20:23], v15 offset:64
    ds_read_b128 v[24:27], v15 offset:128
    ds_read_b128 v[28:31], v15 offset:192
    ds_read_b128 v[32:35], v15 offset:256
    ds_read_b128 v[36:39], v15 offset:320
    ds_read_b128 v[40:43], v15 offset:384
    ds_read_b128 v[44:47], v15 offset:448
    ds_read_b128 v[48:51], v15 offset:512
    ds_read_b128 v[52:55], v15 offset:576
    s_waitcnt lgkmcnt(0)
    ds_read_b128 v[56:59], v15 offset:640
    ds_read_b128 v[60:63], v15 offset:704
    ds_read_b128 v[64:67], v15 offset:768
    ds_read_b128 v[68:71], v15 offset:832
    ds_read_b128 v[72:75], v15 offset:896
    ds_read_b128 v[76:79], v15 offset:960
    ds_read_b128 v[80:83], v15 offset:1024
    ds_read_b128 v[84:87], v15 offset:1088
    ds_read_b128 v[88:91], v15 offset:1152
    ds_read_b128 v[92:95], v15 offset:1216
    s_waitcnt lgkmcnt(0)
    v_mfma_f32_16x16x32_bf16 v[8:11], v[16:19], v[96:99], 0
    v_mfma_f32_16x16x32_bf16 v[12:15], v[16:19], v[100:103], 0
    v_mfma_f32_16x16x32_bf16 v[8:11], v[20:23], v[104:107], v[8:11]
    v_mfma_f32_16x16x32_bf16 v[12:15], v[20:23], v[108:111], v[12:15]
    v_mfma_f32_16x16x32_bf16 v[8:11], v[24:27], v[112:115], v[8:11]
    v_mfma_f32_16x16x32_bf16 v[12:15], v[24:27], v[116:119], v[12:15]
    v_mfma_f32_16x16x32_bf16 v[8:11], v[28:31], v[120:123], v[8:11]
    v_mfma_f32_16x16x32_bf16 v[12:15], v[28:31], v[124:127], v[12:15]
    v_mfma_f32_16x16x32_bf16 v[8:11], v[32:35], v[128:131], v[8:11]
    v_mfma_f32_16x16x32_bf16 v[12:15], v[32:35], v[132:135], v[12:15]
    v_mfma_f32_16x16x32_bf16 v[8:11], v[36:39], v[136:139], v[8:11]
    v_mfma_f32_16x16x32_bf16 v[12:15], v[36:39], v[140:143], v[12:15]
    v_mfma_f32_16x16x32_bf16 v[8:11], v[40:43], v[144:147], v[8:11]
    v_mfma_f32_16x16x32_bf16 v[12:15], v[40:43], v[148:151], v[12:15]
    v_mfma_f32_16x16x32_bf16 v[8:11], v[44:47], v[152:155], v[8:11]
    v_mfma_f32_16x16x32_bf16 v[12:15], v[44:47], v[156:159], v[12:15]
    v_mfma_f32_16x16x32_bf16 v[8:11], v[48:51], v[160:163], v[8:11]
    v_mfma_f32_16x16x32_bf16 v[12:15], v[48:51], v[164:167], v[12:15]
    v_mfma_f32_16x16x32_bf16 v[8:11], v[52:55], v[168:171], v[8:11]
    v_mfma_f32_16x16x32_bf16 v[12:15], v[52:55], v[172:175], v[12:15]
    v_mfma_f32_16x16x32_bf16 v[8:11], v[56:59], v[176:179], v[8:11]
    v_mfma_f32_16x16x32_bf16 v[12:15], v[56:59], v[180:183], v[12:15]
    v_mfma_f32_16x16x32_bf16 v[8:11], v[60:63], v[184:187], v[8:11]
    v_mfma_f32_16x16x32_bf16 v[12:15], v[60:63], v[188:191], v[12:15]
    v_mfma_f32_16x16x32_bf16 v[8:11], v[64:67], v[192:195], v[8:11]
    v_mfma_f32_16x16x32_bf16 v[12:15], v[64:67], v[196:199], v[12:15]
    v_mfma_f32_16x16x32_bf16 v[8:11], v[68:71], v[200:203], v[8:11]
    v_mfma_f32_16x16x32_bf16 v[12:15], v[68:71], v[204:207], v[12:15]
    v_mfma_f32_16x16x32_bf16 v[8:11], v[72:75], v[208:211], v[8:11]
    v_mfma_f32_16x16x32_bf16 v[12:15], v[72:75], v[212:215], v[12:15]
    v_mfma_f32_16x16x32_bf16 v[8:11], v[76:79], v[216:219], v[8:11]
    v_mfma_f32_16x16x32_bf16 v[12:15], v[76:79], v[220:223], v[12:15]
    v_mfma_f32_16x16x32_bf16 v[8:11], v[80:83], v[224:227], v[8:11]
    v_mfma_f32_16x16x32_bf16 v[12:15], v[80:83], v[228:231], v[12:15]
    v_mfma_f32_16x16x32_bf16 v[8:11], v[84:87], v[232:235], v[8:11]
    v_mfma_f32_16x16x32_bf16 v[12:15], v[84:87], v[236:239], v[12:15]
    v_mfma_f32_16x16x32_bf16 v[8:11], v[88:91], v[240:243], v[8:11]
    v_mfma_f32_16x16x32_bf16 v[12:15], v[88:91], v[244:247], v[12:15]
    v_mfma_f32_16x16x32_bf16 v[8:11], v[92:95], v[248:251], v[8:11]
    v_mfma_f32_16x16x32_bf16 v[12:15], v[92:95], v[252:255], v[12:15]
    s_nop 7
    s_mov_b32 exec_lo, 0xffff0000
    v_mov_b32 v8, v12
    s_mov_b32 exec_lo, -1
    v_mul_f32 v8, 0xbfb8aa3b, v8
    v_exp_f32 v8, v8
    s_nop 0
    v_add_f32 v8, 1.0, v8
    v_rcp_f32 v8, v8
L_nog:
    v_lshlrev_b32 v9, 2, v0
    s_lshl_b32 s11, s84, 7
    s_add_u32 s11, s11, 32768
    s_cmp_eq_u32 s9, 0
    s_cselect_b32 s89, s11, 1073741824
    s_waitcnt vmcnt(0) lgkmcnt(0)
    s_barrier
    s_cmp_eq_u32 s3, 0
    s_cbranch_scc1 L_fl_5
L_flr_6:
    s_barrier
    s_mov_b32 exec_hi, 0
    buffer_store_dword v8, v9, s[52:55], s89 offen sc1
    s_mov_b64 exec, -1
    s_add_u32 s12, s88, 640
    s_mul_i32 s11, s12, 6554
    s_lshr_b32 s11, s11, 16
    s_mul_i32 s89, s11, 10
    s_sub_u32 s12, s12, s89
    s_add_u32 s89, s11, 4
    s_mul_i32 s14, s89, 13108
    s_lshr_b32 s14, s14, 16
    s_mul_i32 s13, s14, 160
    s_mulk_i32 s14, 5
    s_sub_u32 s89, s89, s14
    s_mul_i32 s14, s89, 40
    s_cmp_eq_u32 s89, 4
    s_cselect_b32 s89, 16, s14
    s_cselect_b32 s14, 40, 4
    s_cselect_b32 s15, 80, 20
    s_cselect_b32 s92, 20, 8
    s_add_u32 s13, s13, s89
    s_sub_u32 s13, s13, 1920
    v_mad_u32_u24 v7, v3, s92, v6
    v_mul_u32_u24 v7, 1280, v7
    v_add_u32 v7, v7, v5
    s_mulk_i32 s13, 10
    s_add_u32 s13, s13, s12
    s_lshl_b32 s13, s13, 7
    s_mulk_i32 s14, 1280
    s_mulk_i32 s15, 1280
    s_add_u32 m0, s91, 0
    s_add_u32 s89, s13, 0
    buffer_load_dwordx4 v7, s[56:59], s89 offen lds
    s_add_u32 m0, s91, 1024
    s_add_u32 s89, s13, s14
    buffer_load_dwordx4 v7, s[56:59], s89 offen lds
    s_add_u32 s13, s13, s15
    s_add_u32 m0, s91, 2048
    s_add_u32 s89, s13, 0
    buffer_load_dwordx4 v7, s[56:59], s89 offen lds
    s_add_u32 m0, s91, 3072
    s_add_u32 s89, s13, s14
    buffer_load_dwordx4 v7, s[56:59], s89 offen lds
    v_lshlrev_b32 v96, 4, v0
    s_mul_i32 s15, s80, 20
    v_and_b32 v3, 1, v0
    v_mad_u32_u24 v3, v3, 19, s15
    v_lshrrev_b32 v3, 7, v3
    v_lshrrev_b32 v5, 2, v0
    v_mad_u32_u24 v3, v5, 5, v3
    v_bfe_u32 v6, v0, 1, 1
    v_lshl_add_u32 v6, v6, 3, s3
    s_lshr_b32 s15, s81, 2
    s_mov_b64 exec, 15
    v_mov_b32 v6, s15
    s_mov_b64 exec, -1
    v_lshl_add_u32 v3, v3, 4, v6
    v_lshlrev_b32 v100, 7, v3
    v_bfe_u32 v5, v0, 4, 1
    v_lshlrev_b32 v5, 3, v5
    v_and_b32 v6, 15, v0
    v_lshl_add_u32 v97, v6, 4, v5
    s_mov_b64 exec, 0xfff
    buffer_load_dword v101, v100, s[52:55], 0 offen sc1
    s_mov_b64 exec, -1
    s_waitcnt vmcnt(0)
    v_cmp_gt_u32 vcc, 1, v101
    s_and_b32 s11, vcc_lo, 0xfff
    s_cbranch_scc1 L_plp_8
L_pok_7:
    buffer_load_dwordx4 v[112:115], v96, s[52:55], s90 offen sc1
    buffer_load_dwordx2 v[106:107], v97, s[52:55], s90 offen offset:1024 sc1
    s_add_u32 m0, s1, 0
    s_add_u32 s100, s101, 0
    buffer_load_dwordx4 v96, s[52:55], s100 offen sc1 lds
    buffer_load_dwordx4 v96, s[52:55], s100 offen offset:1024 sc1 lds
    buffer_load_dwordx4 v96, s[52:55], s100 offen offset:2048 sc1 lds
    buffer_load_dwordx4 v96, s[52:55], s100 offen offset:3072 sc1 lds
    s_add_u32 m0, s1, 4096
    s_add_u32 s100, s101, 4096
    buffer_load_dwordx4 v96, s[52:55], s100 offen sc1 lds
    ds_read_b64_tr_b16 v[64:65], v4 offset:0
    ds_read_b64_tr_b16 v[66:67], v4 offset:512
    ds_read_b64_tr_b16 v[68:69], v4 offset:32
    ds_read_b64_tr_b16 v[70:71], v4 offset:544
    ds_read_b64_tr_b16 v[72:73], v4 offset:64
    ds_read_b64_tr_b16 v[74:75], v4 offset:576
    ds_read_b64_tr_b16 v[76:77], v4 offset:96
    ds_read_b64_tr_b16 v[78:79], v4 offset:608
    s_add_u32 s11, s88, 640
    s_lshl_b32 s12, s11, 12
    s_add_u32 s12, s12, 15269888
    s_cmp_ge_u32 s11, 760
    s_cselect_b32 s12, 1073741824, s12
    s_waitcnt lgkmcnt(0)
    s_mov_b32 s95, s12
    v_lshrrev_b32 v3, 5, v0
    v_bfe_u32 v5, v0, 3, 2
    v_and_b32 v6, 3, v0
    v_lshl_add_u32 v5, v5, 2, v6
    v_bfe_u32 v6, v0, 2, 1
    v_lshlrev_b32 v15, 9, v3
    v_lshl_add_u32 v15, v6, 8, v15
    v_lshl_add_u32 v104, v5, 4, v15
    v_mul_u32_u24 v15, 2560, v3
    v_lshl_add_u32 v15, v5, 4, v15
    v_lshl_add_u32 v105, v6, 3, v15
    v_mul_u32_u24 v15, 192, v3
    v_sub_u32 v132, v96, v15
    v_mov_b32 v133, 0xdddddddd
    v_mov_b64 v[110:111], 0
    v_mov_b64 v[120:121], 0
    s_mov_b32 exec_lo, 0x11000000
    s_mov_b32 exec_hi, 0x11000000
    v_mov_b32 v120, 0x3f803f80
    v_mov_b32 v121, 0x3f803f80
    s_mov_b64 exec, -1
    v_mov_b64 v[122:123], v[120:121]
    v_mov_b64 v[124:125], v[120:121]
    v_mov_b64 v[126:127], v[120:121]
    v_mov_b64 v[128:129], v[120:121]
    v_mov_b64 v[130:131], v[120:121]
    v_mfma_f32_32x32x8_bf16 v[136:151], v[110:111], v[110:111], 0
    v_lshlrev_b32 v98, 2, v0
    v_and_b32 v99, 60, v98
    v_and_b32 v98, 124, v98
    s_waitcnt vmcnt(0)
    s_branch L_att
L_p1z:
    s_lshl3_add_u32 s88, s6, s3
    s_and_b32 s8, s3, 3
    s_lshr_b32 s9, s3, 2
    s_mov_b32 s93, 3
    s_getpc_b64 s[12:13]
L_pc:
    s_and_b32 s11, s88, 15
    s_mulk_i32 s11, 2816
    v_lshl_add_u32 v40, v0, 7, s11
    v_min_u32 v40, L_pc-L_code0, v40
    v_mov_b32 v41, s13
    v_sub_co_u32 v40, vcc, s12, v40
    s_nop 1
    v_subbrev_co_u32 v41, vcc, 0, v41, vcc
    s_mov_b64 exec, 0x3fffff
    global_load_dword v42, v[40:41], off
    s_mov_b64 exec, -1
    s_mov_b64 s[96:97], s[20:21]
    s_mov_b64 s[98:99], s[28:29]
    s_mov_b64 s[52:53], s[38:39]
    s_mov_b32 s54, 18644992
    s_mov_b32 s55, 0x20000
    s_mov_b64 s[76:77], s[36:37]
    s_mov_b32 s78, 256
    s_mov_b32 s79, 0x20000
    s_mov_b64 s[48:49], s[24:25]
    s_mov_b32 s50, 2211840
    s_mov_b32 s51, 0x20000
    s_mov_b64 s[60:61], s[26:27]
    s_mov_b32 s62, 3456
    s_mov_b32 s63, 0x20000
    s_mov_b64 s[64:65], s[30:31]
    s_mov_b32 s66, 1280
    s_mov_b32 s67, 0x20000
    s_mov_b64 s[68:69], s[32:33]
    s_mov_b32 s70, 1280
    s_mov_b32 s71, 0x20000
    s_mov_b64 s[56:57], s[20:21]
    s_mov_b32 s58, 819200
    s_mov_b32 s59, 0x20000
    s_mov_b64 s[72:73], s[34:35]
    s_mov_b32 s74, 2621440
    s_mov_b32 s75, 0x20000
    v_mul_u32_u24 v231, 3456, v241
    v_lshl_add_u32 v231, v229, 4, v231
    s_lshl_b32 s11, s7, 8
    s_mul_i32 s12, s3, 27648
    s_add_u32 s11, s11, s12
    v_add_u32 v4, s11, v231
    s_lshl_b32 s11, s7, 4
    s_sub_u32 s11, 215, s11
    v_sub_u32 v231, s11, v229
    v_and_b32 v231, 1073741824, v231
    v_or_b32 v4, v4, v231
    s_lshr_b32 s12, s5, 3
    s_lshl2_add_u32 s80, s4, s12
    s_and_b32 s12, s5, 3
    s_lshl2_add_u32 s82, s4, s12
    s_lshr_b32 s83, s5, 2
    s_and_b32 s12, s5, 7
    s_lshl3_add_u32 s81, s12, s3
    s_lshl2_add_u32 s84, s6, s8
    s_mul_i32 s11, s93, 5
    s_sub_u32 s94, s7, s11
    s_mov_b32 s86, 0x000fffff
    s_mov_b32 s87, 0x000fffff
    s_lshl_b32 s11, s80, 6
    s_add_u32 s11, s11, s81
    s_mulk_i32 s11, 1280
    s_add_u32 s90, s11, 65536
    s_mul_i32 s11, s84, 14
    s_add_u32 s11, s11, s7
    s_lshl1_add_u32 s11, s11, s9
    s_lshl_b32 s11, s11, 12
    s_add_u32 s95, s11, 7929856
    s_lshl4_add_u32 s11, s80, s3
    s_mulk_i32 s11, 10240
    s_add_u32 s101, s11, 2686976
    s_mul_i32 s1, s3, 5120
    v_lshlrev_b32 v227, 11, v0
    v_mov_b32 v228, 0
    s_lshl_b32 s11, s3, 19
    s_add_u32 s11, s11, s6
    s_lshl_b32 s11, s11, 7
    s_mov_b64 exec, 0xffff
    buffer_store_dword v228, v227, s[52:55], s11 offen sc1
    s_mov_b64 exec, -1
    v_lshlrev_b32 v40, 7, v0
    s_lshl_b32 s11, s3, 20
    buffer_load_dword v52, v40, s[60:63], s11 offen
    buffer_load_dword v53, v40, s[64:67], s11 offen
    buffer_load_dword v54, v40, s[68:71], s11 offen
    s_mul_i32 s91, s3, 20480
    v_lshlrev_b32 v50, 4, v0
    v_lshrrev_b32 v3, 5, v0
    v_bfe_u32 v6, v0, 3, 2
    v_and_b32 v5, 7, v0
    v_lshlrev_b32 v5, 4, v5
    v_bfe_u32 v4, v0, 2, 2
    v_lshlrev_b32 v4, 7, v4
    v_lshrrev_b32 v7, 4, v0
    v_lshl_add_u32 v4, v7, 10, v4
    v_and_b32 v7, 3, v0
    v_lshl_add_u32 v4, v7, 3, v4
    v_add_u32 v4, s91, v4
    v_mov_b32 v11, 1073741824
    v_mov_b32 v12, 1073741824
    v_mov_b32 v13, 1073741824
    v_mov_b32 v14, 1073741824
    s_add_u32 s12, s88, 0
    s_mul_i32 s11, s12, 6554
    s_lshr_b32 s11, s11, 16
    s_mul_i32 s89, s11, 10
    s_sub_u32 s12, s12, s89
    s_lshl_b32 s89, s11, 5
    s_cmp_ge_u32 s11, 56
    s_cselect_b32 s13, s13, s89
    s_cselect_b32 s14, s14, 4
    s_cselect_b32 s15, s15, 8
    s_cselect_b32 s92, s92, 16
    s_cselect_b64 s[56:57], s[96:97], s[98:99]
    s_mov_b32 s58, 2211840
    s_cselect_b32 s58, 819200, s58
    v_mad_u32_u24 v7, v3, s92, v6
    v_mul_u32_u24 v7, 1280, v7
    v_add_u32 v7, v7, v5
    s_mulk_i32 s13, 10
    s_add_u32 s13, s13, s12
    s_lshl_b32 s13, s13, 7
    s_mulk_i32 s14, 1280
    s_mulk_i32 s15, 1280
    s_add_u32 m0, s91, 0
    s_add_u32 s89, s13, 0
    buffer_load_dwordx4 v7, s[56:59], s89 offen lds
    s_add_u32 m0, s91, 1024
    s_add_u32 s89, s13, s14
    buffer_load_dwordx4 v7, s[56:59], s89 offen lds
    s_add_u32 s13, s13, s15
    s_add_u32 m0, s91, 2048
    s_add_u32 s89, s13, 0
    buffer_load_dwordx4 v7, s[56:59], s89 offen lds
    s_add_u32 m0, s91, 3072
    s_add_u32 s89, s13, s14
    buffer_load_dwordx4 v7, s[56:59], s89 offen lds
    s_add_u32 s12, s88, 128
    s_mul_i32 s11, s12, 6554
    s_lshr_b32 s11, s11, 16
    s_mul_i32 s89, s11, 10
    s_sub_u32 s12, s12, s89
    s_lshl_b32 s89, s11, 5
    s_cmp_ge_u32 s11, 56
    s_cselect_b32 s13, s13, s89
    s_cselect_b32 s14, s14, 4
    s_cselect_b32 s15, s15, 8
    s_cselect_b32 s92, s92, 16
    s_cselect_b64 s[56:57], s[96:97], s[98:99]
    s_mov_b32 s58, 2211840
    s_cselect_b32 s58, 819200, s58
    v_mad_u32_u24 v7, v3, s92, v6
    v_mul_u32_u24 v7, 1280, v7
    v_add_u32 v7, v7, v5
    s_mulk_i32 s13, 10
    s_add_u32 s13, s13, s12
    s_lshl_b32 s13, s13, 7
    s_mulk_i32 s14, 1280
    s_mulk_i32 s15, 1280
    s_add_u32 m0, s91, 4096
    s_add_u32 s89, s13, 0
    buffer_load_dwordx4 v7, s[56:59], s89 offen lds
    s_add_u32 m0, s91, 5120
    s_add_u32 s89, s13, s14
    buffer_load_dwordx4 v7, s[56:59], s89 offen lds
    s_add_u32 s13, s13, s15
    s_add_u32 m0, s91, 6144
    s_add_u32 s89, s13, 0
    buffer_load_dwordx4 v7, s[56:59], s89 offen lds
    s_add_u32 m0, s91, 7168
    s_add_u32 s89, s13, s14
    buffer_load_dwordx4 v7, s[56:59], s89 offen lds
    s_waitcnt vmcnt(11)
    v_mov_b32 v255, 1
    s_lshl_b32 s11, s3, 19
    s_lshl2_add_u32 s11, s6, s11
    s_mov_b64 exec, 1
    buffer_store_dword v255, off, s[76:79], s11 sc1
    s_mov_b64 exec, -1
    s_add_u32 s12, s88, 256
    s_mul_i32 s11, s12, 6554
    s_lshr_b32 s11, s11, 16
    s_mul_i32 s89, s11, 10
    s_sub_u32 s12, s12, s89
    s_lshl_b32 s89, s11, 5
    s_cmp_ge_u32 s11, 56
    s_cselect_b32 s13, s13, s89
    s_cselect_b32 s14, s14, 4
    s_cselect_b32 s15, s15, 8
    s_cselect_b32 s92, s92, 16
    s_cselect_b64 s[56:57], s[96:97], s[98:99]
    s_mov_b32 s58, 2211840
    s_cselect_b32 s58, 819200, s58
    v_mad_u32_u24 v7, v3, s92, v6
    v_mul_u32_u24 v7, 1280, v7
    v_add_u32 v7, v7, v5
    s_mulk_i32 s13, 10
    s_add_u32 s13, s13, s12
    s_lshl_b32 s13, s13, 7
    s_mulk_i32 s14, 1280
    s_mulk_i32 s15, 1280
    s_add_u32 m0, s91, 8192
    s_add_u32 s89, s13, 0
    buffer_load_dwordx4 v7, s[56:59], s89 offen lds
    s_add_u32 m0, s91, 9216
    s_add_u32 s89, s13, s14
    buffer_load_dwordx4 v7, s[56:59], s89 offen lds
    s_add_u32 s13, s13, s15
    s_add_u32 m0, s91, 10240
    s_add_u32 s89, s13, 0
    buffer_load_dwordx4 v7, s[56:59], s89 offen lds
    s_add_u32 m0, s91, 11264
    s_add_u32 s89, s13, s14
    buffer_load_dwordx4 v7, s[56:59], s89 offen lds
    s_add_u32 s12, s88, 384
    s_mul_i32 s11, s12, 6554
    s_lshr_b32 s11, s11, 16
    s_mul_i32 s89, s11, 10
    s_sub_u32 s12, s12, s89
    s_lshl_b32 s89, s11, 5
    s_cmp_ge_u32 s11, 56
    s_cselect_b32 s13, s13, s89
    s_cselect_b32 s14, s14, 4
    s_cselect_b32 s15, s15, 8
    s_cselect_b32 s92, s92, 16
    s_cselect_b64 s[56:57], s[96:97], s[98:99]
    s_mov_b32 s58, 2211840
    s_cselect_b32 s58, 819200, s58
    v_mad_u32_u24 v7, v3, s92, v6
    v_mul_u32_u24 v7, 1280, v7
    v_add_u32 v7, v7, v5
    s_mulk_i32 s13, 10
    s_add_u32 s13, s13, s12
    s_lshl_b32 s13, s13, 7
    s_mulk_i32 s14, 1280
    s_mulk_i32 s15, 1280
    s_add_u32 m0, s91, 12288
    s_add_u32 s89, s13, 0
    buffer_load_dwordx4 v7, s[56:59], s89 offen lds
    s_add_u32 m0, s91, 13312
    s_add_u32 s89, s13, s14
    buffer_load_dwordx4 v7, s[56:59], s89 offen lds
    s_add_u32 s13, s13, s15
    s_add_u32 m0, s91, 14336
    s_add_u32 s89, s13, 0
    buffer_load_dwordx4 v7, s[56:59], s89 offen lds
    s_add_u32 m0, s91, 15360
    s_add_u32 s89, s13, s14
    buffer_load_dwordx4 v7, s[56:59], s89 offen lds
    s_waitcnt vmcnt(13)
    ds_read_b64_tr_b16 v[64:65], v4 offset:0
    ds_read_b64_tr_b16 v[66:67], v4 offset:512
    ds_read_b64_tr_b16 v[68:69], v4 offset:32
    ds_read_b64_tr_b16 v[70:71], v4 offset:544
    ds_read_b64_tr_b16 v[72:73], v4 offset:64
    ds_read_b64_tr_b16 v[74:75], v4 offset:576
    ds_read_b64_tr_b16 v[76:77], v4 offset:96
    ds_read_b64_tr_b16 v[78:79], v4 offset:608
    s_add_u32 s11, s88, 0
    s_lshl_b32 s12, s11, 12
    s_add_u32 s12, s12, 15269888
    s_cmp_ge_u32 s11, 760
    s_cselect_b32 s12, 1073741824, s12
    s_waitcnt lgkmcnt(0)
    buffer_store_dwordx4 v[64:67], v50, s[52:55], s12 offen offset:0 sc1
    buffer_store_dwordx4 v[68:71], v50, s[52:55], s12 offen offset:1024 sc1
    buffer_store_dwordx4 v[72:75], v50, s[52:55], s12 offen offset:2048 sc1
    buffer_store_dwordx4 v[76:79], v50, s[52:55], s12 offen offset:3072 sc1
    s_add_u32 s12, s88, 512
    s_mul_i32 s11, s12, 6554
    s_lshr_b32 s11, s11, 16
    s_mul_i32 s89, s11, 10
    s_sub_u32 s12, s12, s89
    s_add_u32 s89, s11, 4
    s_mul_i32 s14, s89, 13108
    s_lshr_b32 s14, s14, 16
    s_mul_i32 s13, s14, 160
    s_mulk_i32 s14, 5
    s_sub_u32 s89, s89, s14
    s_mul_i32 s14, s89, 40
    s_cmp_eq_u32 s89, 4
    s_cselect_b32 s89, 16, s14
    s_cselect_b32 s14, 40, 4
    s_cselect_b32 s15, 80, 20
    s_cselect_b32 s92, 20, 8
    s_add_u32 s13, s13, s89
    s_sub_u32 s13, s13, 1920
    s_lshl_b32 s89, s11, 5
    s_cmp_ge_u32 s11, 56
    s_cselect_b32 s13, s13, s89
    s_cselect_b32 s14, s14, 4
    s_cselect_b32 s15, s15, 8
    s_cselect_b32 s92, s92, 16
    s_cselect_b64 s[56:57], s[96:97], s[98:99]
    s_mov_b32 s58, 2211840
    s_cselect_b32 s58, 819200, s58
    v_mad_u32_u24 v7, v3, s92, v6
    v_mul_u32_u24 v7, 1280, v7
    v_add_u32 v7, v7, v5
    s_mulk_i32 s13, 10
    s_add_u32 s13, s13, s12
    s_lshl_b32 s13, s13, 7
    s_mulk_i32 s14, 1280
    s_mulk_i32 s15, 1280
    s_add_u32 m0, s91, 16384
    s_add_u32 s89, s13, 0
    buffer_load_dwordx4 v7, s[56:59], s89 offen lds
    s_add_u32 m0, s91, 17408
    s_add_u32 s89, s13, s14
    buffer_load_dwordx4 v7, s[56:59], s89 offen lds
    s_add_u32 s13, s13, s15
    s_add_u32 m0, s91, 18432
    s_add_u32 s89, s13, 0
    buffer_load_dwordx4 v7, s[56:59], s89 offen lds
    s_add_u32 m0, s91, 19456
    s_add_u32 s89, s13, s14
    buffer_load_dwordx4 v7, s[56:59], s89 offen lds
    v_and_b32 v1, 15, v0
    v_lshlrev_b32 v1, 2, v1
    s_lshl_b32 s12, s3, 20
    buffer_load_dword v2, v1, s[76:79], s12 offen sc1
    s_waitcnt vmcnt(18)
    ds_read_b64_tr_b16 v[80:81], v4 offset:4096
    ds_read_b64_tr_b16 v[82:83], v4 offset:4608
    ds_read_b64_tr_b16 v[84:85], v4 offset:4128
    ds_read_b64_tr_b16 v[86:87], v4 offset:4640
    ds_read_b64_tr_b16 v[88:89], v4 offset:4160
    ds_read_b64_tr_b16 v[90:91], v4 offset:4672
    ds_read_b64_tr_b16 v[92:93], v4 offset:4192
    ds_read_b64_tr_b16 v[94:95], v4 offset:4704
    s_add_u32 s11, s88, 128
    s_lshl_b32 s12, s11, 12
    s_add_u32 s12, s12, 15269888
    s_cmp_ge_u32 s11, 760
    s_cselect_b32 s12, 1073741824, s12
    s_waitcnt lgkmcnt(0)
    buffer_store_dwordx4 v[80:83], v50, s[52:55], s12 offen offset:0 sc1
    buffer_store_dwordx4 v[84:87], v50, s[52:55], s12 offen offset:1024 sc1
    buffer_store_dwordx4 v[88:91], v50, s[52:55], s12 offen offset:2048 sc1
    buffer_store_dwordx4 v[92:95], v50, s[52:55], s12 offen offset:3072 sc1
    s_waitcnt vmcnt(17)
    ds_read_b64_tr_b16 v[64:65], v4 offset:8192
    ds_read_b64_tr_b16 v[66:67], v4 offset:8704
    ds_read_b64_tr_b16 v[68:69], v4 offset:8224
    ds_read_b64_tr_b16 v[70:71], v4 offset:8736
    ds_read_b64_tr_b16 v[72:73], v4 offset:8256
    ds_read_b64_tr_b16 v[74:75], v4 offset:8768
    ds_read_b64_tr_b16 v[76:77], v4 offset:8288
    ds_read_b64_tr_b16 v[78:79], v4 offset:8800
    s_add_u32 s11, s88, 256
    s_lshl_b32 s12, s11, 12
    s_add_u32 s12, s12, 15269888
    s_cmp_ge_u32 s11, 760
    s_cselect_b32 s12, 1073741824, s12
    s_waitcnt lgkmcnt(0)
    buffer_store_dwordx4 v[64:67], v50, s[52:55], s12 offen offset:0 sc1
    buffer_store_dwordx4 v[68:71], v50, s[52:55], s12 offen offset:1024 sc1
    buffer_store_dwordx4 v[72:75], v50, s[52:55], s12 offen offset:2048 sc1
    buffer_store_dwordx4 v[76:79], v50, s[52:55], s12 offen offset:3072 sc1
    s_waitcnt vmcnt(17)
    ds_read_b64_tr_b16 v[80:81], v4 offset:12288
    ds_read_b64_tr_b16 v[82:83], v4 offset:12800
    ds_read_b64_tr_b16 v[84:85], v4 offset:12320
    ds_read_b64_tr_b16 v[86:87], v4 offset:12832
    ds_read_b64_tr_b16 v[88:89], v4 offset:12352
    ds_read_b64_tr_b16 v[90:91], v4 offset:12864
    ds_read_b64_tr_b16 v[92:93], v4 offset:12384
    ds_read_b64_tr_b16 v[94:95], v4 offset:12896
    s_add_u32 s11, s88, 384
    s_lshl_b32 s12, s11, 12
    s_add_u32 s12, s12, 15269888
    s_cmp_ge_u32 s11, 760
    s_cselect_b32 s12, 1073741824, s12
    s_waitcnt lgkmcnt(0)
    buffer_store_dwordx4 v[80:83], v50, s[52:55], s12 offen offset:0 sc1
    buffer_store_dwordx4 v[84:87], v50, s[52:55], s12 offen offset:1024 sc1
    buffer_store_dwordx4 v[88:91], v50, s[52:55], s12 offen offset:2048 sc1
    buffer_store_dwordx4 v[92:95], v50, s[52:55], s12 offen offset:3072 sc1
    s_waitcnt vmcnt(13)
    ds_read_b64_tr_b16 v[64:65], v4 offset:16384
    ds_read_b64_tr_b16 v[66:67], v4 offset:16896
    ds_read_b64_tr_b16 v[68:69], v4 offset:16416
    ds_read_b64_tr_b16 v[70:71], v4 offset:16928
    ds_read_b64_tr_b16 v[72:73], v4 offset:16448
    ds_read_b64_tr_b16 v[74:75], v4 offset:16960
    ds_read_b64_tr_b16 v[76:77], v4 offset:16480
    ds_read_b64_tr_b16 v[78:79], v4 offset:16992
    s_add_u32 s11, s88, 512
    s_lshl_b32 s12, s11, 12
    s_add_u32 s12, s12, 15269888
    s_cmp_ge_u32 s11, 760
    s_cselect_b32 s12, 1073741824, s12
    s_waitcnt lgkmcnt(0)
    s_mov_b32 s95, s12
    s_waitcnt vmcnt(12) lgkmcnt(0)
    s_barrier
    s_cmp_eq_u32 s3, 0
    s_cbranch_scc1 L_fl_1
L_flr_2:
    s_barrier
    v_lshlrev_b32 v96, 4, v0
    s_mul_i32 s15, s80, 20
    v_and_b32 v3, 1, v0
    v_mad_u32_u24 v3, v3, 19, s15
    v_lshrrev_b32 v3, 7, v3
    v_lshrrev_b32 v5, 2, v0
    v_mad_u32_u24 v3, v5, 5, v3
    v_bfe_u32 v6, v0, 1, 1
    v_lshl_add_u32 v6, v6, 3, s3
    s_lshr_b32 s15, s81, 2
    s_mov_b64 exec, 15
    v_mov_b32 v6, s15
    s_mov_b64 exec, -1
    v_lshl_add_u32 v3, v3, 4, v6
    v_lshlrev_b32 v100, 7, v3
    v_bfe_u32 v5, v0, 4, 1
    v_lshlrev_b32 v5, 3, v5
    v_and_b32 v6, 15, v0
    v_lshl_add_u32 v97, v6, 4, v5
    s_mov_b64 exec, 0xfff
    buffer_load_dword v101, v100, s[52:55], 0 offen sc1
    s_mov_b64 exec, -1
    s_waitcnt vmcnt(0)
    v_cmp_gt_u32 vcc, 1, v101
    s_and_b32 s11, vcc_lo, 0xfff
    s_cbranch_scc1 L_plp_4
L_pok_3:
    buffer_load_dwordx4 v[112:115], v96, s[52:55], s90 offen sc1
    buffer_load_dwordx2 v[106:107], v97, s[52:55], s90 offen offset:1024 sc1
    s_add_u32 m0, s1, 0
    s_add_u32 s100, s101, 0
    buffer_load_dwordx4 v96, s[52:55], s100 offen sc1 lds
    buffer_load_dwordx4 v96, s[52:55], s100 offen offset:1024 sc1 lds
    buffer_load_dwordx4 v96, s[52:55], s100 offen offset:2048 sc1 lds
    buffer_load_dwordx4 v96, s[52:55], s100 offen offset:3072 sc1 lds
    s_add_u32 m0, s1, 4096
    s_add_u32 s100, s101, 4096
    buffer_load_dwordx4 v96, s[52:55], s100 offen sc1 lds
    v_lshrrev_b32 v3, 5, v0
    v_bfe_u32 v5, v0, 3, 2
    v_and_b32 v6, 3, v0
    v_lshl_add_u32 v5, v5, 2, v6
    v_bfe_u32 v6, v0, 2, 1
    v_lshlrev_b32 v15, 9, v3
    v_lshl_add_u32 v15, v6, 8, v15
    v_lshl_add_u32 v104, v5, 4, v15
    v_mul_u32_u24 v15, 2560, v3
    v_lshl_add_u32 v15, v5, 4, v15
    v_lshl_add_u32 v105, v6, 3, v15
    v_mul_u32_u24 v15, 192, v3
    v_sub_u32 v132, v96, v15
    v_mov_b32 v133, 0xdddddddd
    v_mov_b64 v[110:111], 0
    v_mov_b64 v[120:121], 0
    s_mov_b32 exec_lo, 0x11000000
    s_mov_b32 exec_hi, 0x11000000
    v_mov_b32 v120, 0x3f803f80
    v_mov_b32 v121, 0x3f803f80
    s_mov_b64 exec, -1
    v_mov_b64 v[122:123], v[120:121]
    v_mov_b64 v[124:125], v[120:121]
    v_mov_b64 v[126:127], v[120:121]
    v_mov_b64 v[128:129], v[120:121]
    v_mov_b64 v[130:131], v[120:121]
    v_mfma_f32_32x32x8_bf16 v[136:151], v[110:111], v[110:111], 0
    v_lshlrev_b32 v98, 2, v0
    v_and_b32 v99, 60, v98
    v_and_b32 v98, 124, v98
    s_waitcnt vmcnt(0)
    s_branch L_att
L_fb:
    v_add_u32 v104, 0xfffe2000, v104
    v_add_u32 v105, 0xfffe2000, v105
    v_add_u32 v132, 0xfffe2000, v132
    v_mov_b32 v168, 0xff800000
    s_mov_b32 s12, 0
L_fb0:
    ds_read_b128 v[116:119], v104 offset:0
    ds_read_b64 v[110:111], v105 offset:1024
    s_waitcnt lgkmcnt(0)
    v_mfma_f32_32x32x16_bf16 v[152:167], v[116:119], v[112:115], 0
    v_mfma_f32_32x32x8_bf16 v[152:167], v[110:111], v[106:107], v[152:167]
    s_nop 11
    v_max3_f32 v168, v168, v152, v153
    v_max3_f32 v168, v168, v154, v155
    v_max3_f32 v168, v168, v156, v157
    v_max3_f32 v168, v168, v158, v159
    v_max3_f32 v168, v168, v160, v161
    v_max3_f32 v168, v168, v162, v163
    v_max3_f32 v168, v168, v164, v165
    v_max3_f32 v168, v168, v166, v167
    ds_read_b128 v[116:119], v104 offset:2560
    ds_read_b64 v[110:111], v105 offset:1024
    s_waitcnt lgkmcnt(0)
    v_mfma_f32_32x32x16_bf16 v[152:167], v[116:119], v[112:115], 0
    v_mfma_f32_32x32x8_bf16 v[152:167], v[110:111], v[108:109], v[152:167]
    s_nop 11
    v_max3_f32 v168, v168, v152, v153
    v_max3_f32 v168, v168, v154, v155
    v_max3_f32 v168, v168, v156, v157
    v_max3_f32 v168, v168, v158, v159
    v_max3_f32 v168, v168, v160, v161
    v_max3_f32 v168, v168, v162, v163
    v_max3_f32 v168, v168, v164, v165
    v_max3_f32 v168, v168, v166, v167
    v_add_u32 v104, 5120, v104
    v_add_u32 v105, 5120, v105
    s_add_u32 s12, s12, 1
    s_cmp_lt_u32 s12, 32
    s_cbranch_scc1 L_fb0
    v_mov_b32 v169, v168
    v_add_u32 v104, 0xfffd8000, v104
    v_add_u32 v105, 0xfffd8000, v105
    v_permlane32_swap_b32 v168, v169
    s_nop 1
    v_max_f32 v168, v168, v169
    v_mov_b32 v136, 0
    v_mov_b32 v137, 0
    v_mov_b32 v138, 0
    v_mov_b32 v139, 0
    v_mov_b32 v140, 0
    v_mov_b32 v141, 0
    v_mov_b32 v142, 0
    v_mov_b32 v143, 0
    v_mov_b32 v144, 0
    v_mov_b32 v145, 0
    v_mov_b32 v146, 0
    v_mov_b32 v147, 0
    v_mov_b32 v148, 0
    v_mov_b32 v149, 0
    v_mov_b32 v150, 0
    v_mov_b32 v151, 0
    s_mov_b32 s12, 0
L_fb1:
    ds_read_b128 v[116:119], v104 offset:0
    ds_read_b64 v[110:111], v105 offset:1024
    s_mov_b64 exec, s[86:87]
    ds_read_b128 v[120:123], v132 offset:1280
    ds_read_b128 v[124:127], v132 offset:1920
    s_mov_b64 exec, -1
    s_waitcnt lgkmcnt(0)
    v_mfma_f32_32x32x16_bf16 v[152:167], v[116:119], v[112:115], 0
    v_mfma_f32_32x32x8_bf16 v[152:167], v[110:111], v[106:107], v[152:167]
    s_nop 11
    v_sub_f32 v152, v152, v168
    v_exp_f32 v152, v152
    v_sub_f32 v153, v153, v168
    v_exp_f32 v153, v153
    v_sub_f32 v154, v154, v168
    v_exp_f32 v154, v154
    v_sub_f32 v155, v155, v168
    v_exp_f32 v155, v155
    v_sub_f32 v156, v156, v168
    v_exp_f32 v156, v156
    v_sub_f32 v157, v157, v168
    v_exp_f32 v157, v157
    v_sub_f32 v158, v158, v168
    v_exp_f32 v158, v158
    v_sub_f32 v159, v159, v168
    v_exp_f32 v159, v159
    v_sub_f32 v160, v160, v168
    v_exp_f32 v160, v160
    v_sub_f32 v161, v161, v168
    v_exp_f32 v161, v161
    v_sub_f32 v162, v162, v168
    v_exp_f32 v162, v162
    v_sub_f32 v163, v163, v168
    v_exp_f32 v163, v163
    v_sub_f32 v164, v164, v168
    v_exp_f32 v164, v164
    v_sub_f32 v165, v165, v168
    v_exp_f32 v165, v165
    v_sub_f32 v166, v166, v168
    v_exp_f32 v166, v166
    v_sub_f32 v167, v167, v168
    v_exp_f32 v167, v167
    s_nop 1
    v_smfmac_f32_32x32x32_bf16 v[136:151], v[120:123], v[152:159], v133
    v_smfmac_f32_32x32x32_bf16 v[136:151], v[124:127], v[160:167], v133
    s_nop 7
    ds_read_b128 v[116:119], v104 offset:2560
    ds_read_b64 v[110:111], v105 offset:1024
    s_mov_b64 exec, s[86:87]
    ds_read_b128 v[120:123], v132 offset:3840
    ds_read_b128 v[124:127], v132 offset:4480
    s_mov_b64 exec, -1
    s_waitcnt lgkmcnt(0)
    v_mfma_f32_32x32x16_bf16 v[152:167], v[116:119], v[112:115], 0
    v_mfma_f32_32x32x8_bf16 v[152:167], v[110:111], v[108:109], v[152:167]
    s_nop 11
    v_sub_f32 v152, v152, v168
    v_exp_f32 v152, v152
    v_sub_f32 v153, v153, v168
    v_exp_f32 v153, v153
    v_sub_f32 v154, v154, v168
    v_exp_f32 v154, v154
    v_sub_f32 v155, v155, v168
    v_exp_f32 v155, v155
    v_sub_f32 v156, v156, v168
    v_exp_f32 v156, v156
    v_sub_f32 v157, v157, v168
    v_exp_f32 v157, v157
    v_sub_f32 v158, v158, v168
    v_exp_f32 v158, v158
    v_sub_f32 v159, v159, v168
    v_exp_f32 v159, v159
    v_sub_f32 v160, v160, v168
    v_exp_f32 v160, v160
    v_sub_f32 v161, v161, v168
    v_exp_f32 v161, v161
    v_sub_f32 v162, v162, v168
    v_exp_f32 v162, v162
    v_sub_f32 v163, v163, v168
    v_exp_f32 v163, v163
    v_sub_f32 v164, v164, v168
    v_exp_f32 v164, v164
    v_sub_f32 v165, v165, v168
    v_exp_f32 v165, v165
    v_sub_f32 v166, v166, v168
    v_exp_f32 v166, v166
    v_sub_f32 v167, v167, v168
    v_exp_f32 v167, v167
    s_nop 1
    v_smfmac_f32_32x32x32_bf16 v[136:151], v[120:123], v[152:159], v133
    v_smfmac_f32_32x32x32_bf16 v[136:151], v[124:127], v[160:167], v133
    s_nop 7
    v_add_u32 v104, 5120, v104
    v_add_u32 v105, 5120, v105
    v_add_u32 v132, 5120, v132
    s_add_u32 s12, s12, 1
    s_cmp_lt_u32 s12, 32
    s_cbranch_scc1 L_fb1
    s_nop 7
    s_branch L_fb_back

.section .rodata,"a"
.p2align 6
.amdhsa_kernel gated_mix__mha_block__dense_activation_squared_relu__prompt_kernel
  .amdhsa_next_free_vgpr 256
  .amdhsa_next_free_sgpr 102
  .amdhsa_accum_offset 256
  .amdhsa_group_segment_fixed_size 0
  .amdhsa_kernarg_size 96
  .amdhsa_user_sgpr_count 2
  .amdhsa_user_sgpr_kernarg_segment_ptr 1
  .amdhsa_system_sgpr_workgroup_id_x 1
  .amdhsa_float_denorm_mode_32 3
.end_amdhsa_kernel
```
